```python
import torch

def _softmax(x, axis=-1):
    return torch.softmax(x, dim=axis)
def _gelu(x):
    return torch.nn.functional.gelu(x, approximate="tanh")
def _silu(x):
    return torch.nn.functional.silu(x)
def _sigmoid(x):
    return torch.sigmoid(x)
def _layernorm(x, axis=-1, eps=1e-5):
    m = x.mean(dim=axis, keepdim=True)
    v = x.var(dim=axis, keepdim=True, unbiased=False)
    return (x - m) / torch.sqrt(v + eps)
def _scatter_add(tgt, idx, src, axis=0):
    return tgt.clone().index_add_(axis, idx, src)
def _segment_sum(src, seg, n):
    out = torch.zeros((n,) + src.shape[1:], dtype=src.dtype)
    return out.index_add_(0, seg, src)
def _pad(x, pw):
    flat = tuple(v for pair in reversed(pw) for v in pair)
    return torch.nn.functional.pad(x, flat)

kernel_name = 'parallel_sum__mha_block_cached__dense_activation_silu__decode'

def setup_inputs():

    _w = (lambda a: (lambda t: t.to(torch.bfloat16) if t.is_floating_point() else t)(torch.as_tensor(a)))
    def _A_setup():
        B, Sq, D = 1, 1, 576
        H, Sk, Dh = 32, 32768, 128
        return {
            "x": _w((lambda *s: torch.randn(*s, dtype=torch.bfloat16) * 0.05)(B, Sq, D)),
            "k_cache": _w((lambda *s: torch.randn(*s, dtype=torch.bfloat16) * 3.2)(B, H, Sk, Dh)),
            "v_cache": _w((lambda *s: torch.randn(*s, dtype=torch.bfloat16) * 0.8)(B, H, Sk, Dh)),
            "wq": _w((lambda *s: torch.randn(*s, dtype=torch.bfloat16) * 3.2)(D, H * Dh) * (D ** -0.5)),
            "wo": _w((lambda *s: torch.randn(*s, dtype=torch.bfloat16) * 0.8)(H * Dh, D) * ((H * Dh) ** -0.5)),
        }
    _A_in = _A_setup()

    def _B_setup():
        B, S, D, F = 1, 1, 576, 4608
        return {
            "x": _w((lambda *s: torch.randn(*s, dtype=torch.bfloat16) * 0.05)(B, S, D)),
            "w1": _w((lambda *s: torch.randn(*s, dtype=torch.bfloat16) * 3.2)(D, F) * (D ** -0.5)),
            "w2": _w((lambda *s: torch.randn(*s, dtype=torch.bfloat16) * 0.4)(F, D) * (F ** -0.5)),
        }
    _B_in = _B_setup()

    return {
        "A_x": _A_in["x"],
        "A_k_cache": _A_in["k_cache"],
        "A_v_cache": _A_in["v_cache"],
        "A_wq": _A_in["wq"],
        "A_wo": _A_in["wo"],
        "B_x": _B_in["x"],
        "B_w1": _B_in["w1"],
        "B_w2": _B_in["w2"],
    }

def reference(A_x, A_k_cache, A_v_cache, A_wq, A_wo, B_x, B_w1, B_w2):
    def _A_ref(x, k_cache, v_cache, wq, wo):
        B, Sq, D = x.shape
        H, Dh = 32, 128
        q = (lambda x, *d: x.permute(*d))((x @ wq).reshape(B, Sq, H, Dh), 0, 2, 1, 3)
        scores = torch.einsum("bhqd,bhkd->bhqk", q, k_cache) * (Dh ** -0.5)
        p = _softmax(scores, axis=-1)
        o = torch.einsum("bhqk,bhkd->bhqd", p, v_cache)
        return (lambda x, *d: x.permute(*d))(o, 0, 2, 1, 3).reshape(B, Sq, H * Dh) @ wo

    def _B_ref(x, w1, w2):
        h = torch.einsum("bsd,df->bsf", x, w1)
        h = _silu(h)
        out = torch.einsum("bsf,fd->bsd", h, w2)
        return out

    x = A_x
    xn = _layernorm(x, axis=-1)
    return x + _A_ref(xn, A_k_cache, A_v_cache, A_wq, A_wo) + _B_ref(xn, B_w1, B_w2)
```

```asm
; @launch grid=(256,1,1) block=(384,1,1) lds=86016
.amdgcn_target "amdgcn-amd-amdhsa--gfx950"
.text
.globl parallel_sum__mha_block_cached__dense_activation_silu__decode_kernel
.p2align 8
.type parallel_sum__mha_block_cached__dense_activation_silu__decode_kernel,@function
parallel_sum__mha_block_cached__dense_activation_silu__decode_kernel:

    s_cmp_ge_u32 s2, 256
    s_cbranch_scc1 L_end
    s_load_dwordx16 s[8:23], s[0:1], 0
    s_load_dwordx4 s[24:27], s[0:1], 64
    s_load_dwordx2 s[28:29], s[0:1], 80

L_pc2:
    s_getpc_b64 s[30:31]
    v_lshlrev_b32 v4, 6, v0
    v_min_u32 v4, L_end-L_pc2, v4
    global_load_dword v48, v4, s[30:31]

    v_lshrrev_b32 v1, 6, v0
    v_and_b32 v0, 63, v0
    v_readfirstlane_b32 s3, v1
    s_lshr_b32 s4, s2, 3
    s_and_b32 s5, s2, 7
    v_lshrrev_b32 v2, 4, v0
    v_and_b32 v3, 15, v0

    s_cmp_eq_u32 s3, 4
    s_cbranch_scc0 L_noinit
    v_lshlrev_b32 v4, 3, v0
    v_mov_b32 v6, -1
    v_mov_b32 v7, -1
    ds_write_b64 v4, v[6:7] offset:53248
    v_mov_b32 v8, 0
    v_mov_b32 v9, 0

    v_mov_b32 v5, 320
    ds_write_b64 v5, v[8:9]
L_noinit:

    s_waitcnt lgkmcnt(0)
    s_load_dword s6, s[28:29], 0
    s_mov_b32 s44, s28
    s_mov_b32 s45, s29
    s_mov_b32 s46, 16777216
    s_mov_b32 s47, 0x20000
    s_cmp_eq_u32 s3, 4
    s_cbranch_scc1 L_helperA
    s_cmp_eq_u32 s3, 5
    s_cbranch_scc1 L_helperB

    s_lshl_b32 s30, s4, 23
    s_add_u32 s32, s10, s30
    s_addc_u32 s33, s11, 0
    s_mov_b32 s34, 0x800000
    s_mov_b32 s35, 0x20000
    s_lshl_b32 s56, s5, 7
    s_add_u32 s56, s56, s3
    s_lshl_b32 s31, s56, 13
    v_lshlrev_b32 v4, 4, v0
    v_add_u32 v5, s31, v4
    v_add_u32 v6, 4096, v5

    s_barrier
    buffer_load_dwordx4 v[64:67], v5, s[32:35], 0 offen offset:0 nt
    buffer_load_dwordx4 v[68:71], v5, s[32:35], 0 offen offset:1024 nt
    buffer_load_dwordx4 v[72:75], v5, s[32:35], 0 offen offset:2048 nt
    buffer_load_dwordx4 v[76:79], v5, s[32:35], 0 offen offset:3072 nt
    buffer_load_dwordx4 v[80:83], v6, s[32:35], 0 offen offset:0 nt

    s_add_u32 s36, s12, s30
    s_addc_u32 s37, s13, 0
    s_mov_b32 s38, 0x800000
    s_mov_b32 s39, 0x20000
    s_mov_b32 s42, 0x800000
    s_mov_b32 s43, 0x20000
    s_mov_b32 s57, s56
    s_mul_i32 s30, s4, 256
    s_add_u32 s30, s30, 4096
    s_add_u32 s64, s28, s30
    s_addc_u32 s65, s29, 0
    s_mul_i32 s84, s4, 8192
    s_add_u32 s84, s84, 1310720
    s_mov_b32 s58, 0
    s_mov_b32 s88, 0x10000
    s_mov_b32 s89, 0
    s_mov_b32 s93, 0
    s_mov_b32 s59, 0
    s_mov_b32 s60, 0x3fb8aa3b
    s_mov_b32 s61, 0x3db504f3
    s_mov_b32 s52, 0xcccccccc
    s_mov_b32 s53, 0xcccccccc
    s_mov_b32 s54, 0xaaaaaaaa
    s_mov_b32 s55, 0xaaaaaaaa

    v_and_b32 v20, 7, v3
    v_and_b32 v21, 1, v3
    v_lshlrev_b32 v21, 4, v21
    v_mov_b32 v12, 0xffff
    v_lshlrev_b32 v21, v21, v12
    v_lshrrev_b32 v20, 1, v20
    v_cmp_eq_u32 vcc, 0, v20
    s_nop 1
    v_cndmask_b32 v12, 0, v21, vcc
    v_cmp_eq_u32 vcc, 1, v20
    s_nop 1
    v_cndmask_b32 v13, 0, v21, vcc
    v_cmp_eq_u32 vcc, 2, v20
    s_nop 1
    v_cndmask_b32 v14, 0, v21, vcc
    v_cmp_eq_u32 vcc, 3, v20
    s_nop 1
    v_cndmask_b32 v15, 0, v21, vcc

    v_mov_b32 v16, 0
    v_mov_b32 v17, 0
    v_mov_b32 v18, 0
    v_mov_b32 v19, 0
    v_mov_b32 v20, 0
    v_mov_b32 v22, 0xff800000
    v_lshlrev_b32 v23, 4, v3
    s_mul_i32 s30, s3, 12288
    s_add_u32 s30, s30, 4096
    v_lshl_add_u32 v47, v0, 2, s30
    s_lshl_b32 s30, s3, 7
    s_add_u32 s30, s30, 53124
    v_mov_b32 v43, s30
    v_mov_b32 v56, v47
    v_lshrrev_b32 v57, 1, v3
    v_lshlrev_b32 v57, 1, v57
    v_lshrrev_b32 v59, 1, v2
    v_add_u32 v57, v57, v59
    v_lshlrev_b32 v57, 3, v57
    v_and_b32 v59, 1, v2
    v_lshlrev_b32 v59, 4, v59
    v_sub_u32 v59, 16, v59
    s_waitcnt lgkmcnt(0)

    s_mul_i32 s6, s6, 0x9E3779B1
    s_add_u32 s6, s6, 0x7F4A7C15
    s_barrier
    v_mov_b32 v41, 324
    s_mov_b32 s49, 0
L_qw:
    ds_read_b32 v42, v41
    s_add_u32 s49, s49, 1
    s_waitcnt lgkmcnt(0)
    v_readfirstlane_b32 s30, v42
    s_cmp_ge_u32 s49, 640000
    s_cbranch_scc1 L_qd
    s_cmp_eq_u32 s30, 0
    s_cbranch_scc0 L_qd
    s_sleep 1
    s_branch L_qw
L_qd:
    ds_read_b128 v[8:11], v23 offset:0
    s_waitcnt lgkmcnt(0)
L_ktile:
    s_add_u32 s58, s58, 1
    s_lshl_b32 s31, s58, 2
    s_add_u32 s30, s31, s56
    s_waitcnt lgkmcnt(0)
    s_mov_b32 s92, s30
    s_mov_b32 s91, s59
    s_bfe_u32 s30, s91, 0x30002
    s_lshl_b32 s30, s30, 7
    s_lshr_b32 s31, s91, 5
    s_lshl_b32 s31, s31, 2
    s_add_u32 s30, s30, s31
    s_and_b32 s31, s91, 3
    s_add_u32 s30, s30, s31
    s_add_u32 s30, s30, 120
    s_cmp_lt_u32 s91, 64
    s_cselect_b32 s62, s30, 1024
    s_cmp_lt_u32 s58, 30
    s_cselect_b32 s62, s92, s62
    s_mov_b32 s59, 0x10000
    s_mov_b32 s85, 0
    s_cmp_lt_u32 s58, 29
    s_cbranch_scc1 L_knotk
    s_cmp_ge_u32 s58, 47
    s_cbranch_scc1 L_knotk
    s_cmp_ge_u32 s62, 1024
    s_cbranch_scc1 L_knotk
    s_mov_b32 s59, 1
    s_atomic_add s59, s[64:65], 0 glc
L_knotk:
    s_cmp_lt_u32 s62, 1024
    s_cselect_b32 s83, 1, 0
    s_cselect_b32 s62, s62, s56
    s_cselect_b32 s40, s32, s36
    s_cselect_b32 s41, s33, s37
    s_lshl_b32 s63, s62, 13
    v_add_u32 v7, s63, v4
    v_add_u32 v46, 4096, v7
    s_waitcnt vmcnt(4)
    v_dot2_f32_bf16 v24, v64, v8, 0
    v_dot2_f32_bf16 v24, v65, v9, v24
    v_dot2_f32_bf16 v24, v66, v10, v24
    v_dot2_f32_bf16 v24, v67, v11, v24
    buffer_load_dwordx4 v[84:87], v6, s[32:35], 0 offen offset:1024 nt
    s_waitcnt vmcnt(4)
    v_dot2_f32_bf16 v25, v68, v8, 0
    v_dot2_f32_bf16 v25, v69, v9, v25
    v_dot2_f32_bf16 v25, v70, v10, v25
    v_dot2_f32_bf16 v25, v71, v11, v25
    buffer_load_dwordx4 v[88:91], v6, s[32:35], 0 offen offset:2048 nt
    s_waitcnt vmcnt(4)
    v_dot2_f32_bf16 v26, v72, v8, 0
    v_dot2_f32_bf16 v26, v73, v9, v26
    v_dot2_f32_bf16 v26, v74, v10, v26
    v_dot2_f32_bf16 v26, v75, v11, v26
    buffer_load_dwordx4 v[92:95], v6, s[32:35], 0 offen offset:3072 nt
    s_waitcnt vmcnt(4)
    v_dot2_f32_bf16 v27, v76, v8, 0
    v_dot2_f32_bf16 v27, v77, v9, v27
    v_dot2_f32_bf16 v27, v78, v10, v27
    v_dot2_f32_bf16 v27, v79, v11, v27
    buffer_load_dwordx4 v[64:67], v7, s[40:43], 0 offen offset:0 nt
    s_waitcnt vmcnt(4)
    v_dot2_f32_bf16 v28, v80, v8, 0
    v_dot2_f32_bf16 v28, v81, v9, v28
    v_dot2_f32_bf16 v28, v82, v10, v28
    v_dot2_f32_bf16 v28, v83, v11, v28
    buffer_load_dwordx4 v[68:71], v7, s[40:43], 0 offen offset:1024 nt
    s_waitcnt vmcnt(4)
    v_dot2_f32_bf16 v29, v84, v8, 0
    v_dot2_f32_bf16 v29, v85, v9, v29
    v_dot2_f32_bf16 v29, v86, v10, v29
    v_dot2_f32_bf16 v29, v87, v11, v29
    buffer_load_dwordx4 v[72:75], v7, s[40:43], 0 offen offset:2048 nt
    s_waitcnt vmcnt(4)
    v_dot2_f32_bf16 v30, v88, v8, 0
    v_dot2_f32_bf16 v30, v89, v9, v30
    v_dot2_f32_bf16 v30, v90, v10, v30
    v_dot2_f32_bf16 v30, v91, v11, v30
    buffer_load_dwordx4 v[76:79], v7, s[40:43], 0 offen offset:3072 nt
    s_waitcnt vmcnt(4)
    v_dot2_f32_bf16 v31, v92, v8, 0
    v_dot2_f32_bf16 v31, v93, v9, v31
    v_dot2_f32_bf16 v31, v94, v10, v31
    v_dot2_f32_bf16 v31, v95, v11, v31
    buffer_load_dwordx4 v[80:83], v46, s[40:43], 0 offen offset:0 nt
    v_add_f32_dpp v32, v24, v24 row_ror:8 row_mask:0xf bank_mask:0x3
    v_add_f32_dpp v32, v28, v28 row_ror:8 row_mask:0xf bank_mask:0xc
    v_add_f32_dpp v33, v25, v25 row_ror:8 row_mask:0xf bank_mask:0x3
    v_add_f32_dpp v33, v29, v29 row_ror:8 row_mask:0xf bank_mask:0xc
    v_add_f32_dpp v34, v26, v26 row_ror:8 row_mask:0xf bank_mask:0x3
    v_add_f32_dpp v34, v30, v30 row_ror:8 row_mask:0xf bank_mask:0xc
    v_add_f32_dpp v35, v27, v27 row_ror:8 row_mask:0xf bank_mask:0x3
    v_add_f32_dpp v35, v31, v31 row_ror:8 row_mask:0xf bank_mask:0xc
    v_add_f32_dpp v36, v32, v32 row_shl:4 row_mask:0xf bank_mask:0x5
    v_add_f32_dpp v36, v34, v34 row_shr:4 row_mask:0xf bank_mask:0xa
    v_add_f32_dpp v37, v33, v33 row_shl:4 row_mask:0xf bank_mask:0x5
    v_add_f32_dpp v37, v35, v35 row_shr:4 row_mask:0xf bank_mask:0xa
    v_mov_b32 v5, v7
    v_add_f32_dpp v38, v36, v36 quad_perm:[2,3,0,1] row_mask:0xf bank_mask:0xf
    v_add_f32_dpp v39, v37, v37 quad_perm:[2,3,0,1] row_mask:0xf bank_mask:0xf
    v_cndmask_b32 v40, v38, v39, s[52:53]
    v_mov_b32 v6, v46
    v_mov_b32 v41, s57
    v_add_f32_dpp v40, v40, v40 quad_perm:[1,0,3,2] row_mask:0xf bank_mask:0xf
    v_cvt_pk_bf16_f32 v40, v40, v40
    v_and_b32 v40, 0xffff0000, v40
    v_mul_f32 v40, s61, v40
    v_cvt_pk_bf16_f32 v40, v40, v40
    v_and_b32 v40, 0xffff0000, v40
    ds_write_b32 v56, v40
    s_cmp_gt_u32 s58, 30
    s_cbranch_scc0 L_noid
    s_lshl_b32 s30, s58, 2
    v_add_u32 v42, s30, v43
    ds_write_b32 v42, v41 offset:0
L_noid:
    v_max_f32 v22, v22, v40
    v_add_u32 v56, 256, v56
    s_mov_b32 s57, s91
    s_cmp_eq_u32 s83, 1
    s_cbranch_scc1 L_ktile
    v_mov_b32 v41, 320
    v_mov_b32 v42, 1
    s_waitcnt lgkmcnt(0)
    ds_add_u32 v41, v42
    ds_read_b32 v58, v47
    s_nop 1
    v_max_f32_dpp v22, v22, v22 row_ror:8 row_mask:0xf bank_mask:0xf
    s_nop 1
    v_max_f32_dpp v22, v22, v22 row_ror:4 row_mask:0xf bank_mask:0xf
    s_nop 1
    v_max_f32_dpp v22, v22, v22 row_ror:2 row_mask:0xf bank_mask:0xf
    v_mov_b32 v41, v22
    s_nop 1
    v_permlane16_swap_b32 v22, v41
    v_max_f32 v22, v22, v41
    v_mov_b32 v41, v22
    s_nop 1
    v_permlane32_swap_b32 v22, v41
    v_max_f32 v22, v22, v41
    v_mul_f32 v21, s60, v22
    v_add_u32 v56, 256, v47
    s_mov_b32 s94, s58
    s_mov_b32 s58, 0
    s_add_u32 s64, s64, 128
    s_addc_u32 s65, s65, 0
L_vtile:
    s_waitcnt lgkmcnt(0)
    s_add_u32 s58, s58, 1
    s_lshl_b32 s30, s58, 2
    s_add_u32 s62, s30, s56
    v_mov_b32 v40, v58
    ds_read_b32 v58, v56
    v_add_u32 v56, 256, v56
    s_lshl_b32 s63, s62, 13
    v_add_u32 v7, s63, v4
    v_add_u32 v46, 4096, v7
    v_cmp_lt_f32 vcc, v22, v40
    s_cbranch_vccnz L_rares
L_backs:
    v_fma_f32 v41, v40, s60, -v21
    v_exp_f32 v41, v41
    s_nop 0
    v_add_f32 v20, v20, v41
    v_cvt_pk_bf16_f32 v42, v41, v41
    v_and_b32 v43, 0xffff0000, v42
    v_sub_f32 v43, v41, v43
    v_cvt_pk_bf16_f32 v43, v43, v43
    v_cndmask_b32 v42, v42, v43, s[54:55]
    s_nop 1
    v_mov_b32_dpp v44, v42 row_newbcast:0 row_mask:0xf bank_mask:0x3
    v_mov_b32_dpp v44, v42 row_newbcast:1 row_mask:0xf bank_mask:0xc
    v_and_b32 v48, v44, v12
    v_and_b32 v49, v44, v13
    v_and_b32 v50, v44, v14
    v_and_b32 v51, v44, v15
    v_mov_b32_dpp v45, v42 row_newbcast:2 row_mask:0xf bank_mask:0x3
    v_mov_b32_dpp v45, v42 row_newbcast:3 row_mask:0xf bank_mask:0xc
    v_and_b32 v52, v45, v12
    v_and_b32 v53, v45, v13
    v_and_b32 v54, v45, v14
    v_and_b32 v55, v45, v15
    s_waitcnt vmcnt(4)
    v_mfma_f32_16x16x32_bf16 v[16:19], v[64:67], v[48:51], v[16:19]
    buffer_load_dwordx4 v[84:87], v6, s[36:39], 0 offen offset:1024 nt
    v_mov_b32_dpp v44, v42 row_newbcast:4 row_mask:0xf bank_mask:0x3
    v_mov_b32_dpp v44, v42 row_newbcast:5 row_mask:0xf bank_mask:0xc
    v_and_b32 v48, v44, v12
    v_and_b32 v49, v44, v13
    v_and_b32 v50, v44, v14
    v_and_b32 v51, v44, v15
    s_waitcnt vmcnt(4)
    v_mfma_f32_16x16x32_bf16 v[16:19], v[68:71], v[52:55], v[16:19]
    buffer_load_dwordx4 v[88:91], v6, s[36:39], 0 offen offset:2048 nt
    v_mov_b32_dpp v45, v42 row_newbcast:6 row_mask:0xf bank_mask:0x3
    v_mov_b32_dpp v45, v42 row_newbcast:7 row_mask:0xf bank_mask:0xc
    v_and_b32 v52, v45, v12
    v_and_b32 v53, v45, v13
    v_and_b32 v54, v45, v14
    v_and_b32 v55, v45, v15
    s_waitcnt vmcnt(4)
    v_mfma_f32_16x16x32_bf16 v[16:19], v[72:75], v[48:51], v[16:19]
    buffer_load_dwordx4 v[92:95], v6, s[36:39], 0 offen offset:3072 nt
    v_mov_b32_dpp v44, v42 row_newbcast:8 row_mask:0xf bank_mask:0x3
    v_mov_b32_dpp v44, v42 row_newbcast:9 row_mask:0xf bank_mask:0xc
    v_and_b32 v48, v44, v12
    v_and_b32 v49, v44, v13
    v_and_b32 v50, v44, v14
    v_and_b32 v51, v44, v15
    s_waitcnt vmcnt(4)
    v_mfma_f32_16x16x32_bf16 v[16:19], v[76:79], v[52:55], v[16:19]
    buffer_load_dwordx4 v[64:67], v7, s[36:39], 0 offen offset:0 nt
    v_mov_b32_dpp v45, v42 row_newbcast:10 row_mask:0xf bank_mask:0x3
    v_mov_b32_dpp v45, v42 row_newbcast:11 row_mask:0xf bank_mask:0xc
    v_and_b32 v52, v45, v12
    v_and_b32 v53, v45, v13
    v_and_b32 v54, v45, v14
    v_and_b32 v55, v45, v15
    s_waitcnt vmcnt(4)
    v_mfma_f32_16x16x32_bf16 v[16:19], v[80:83], v[48:51], v[16:19]
    buffer_load_dwordx4 v[68:71], v7, s[36:39], 0 offen offset:1024 nt
    v_mov_b32_dpp v44, v42 row_newbcast:12 row_mask:0xf bank_mask:0x3
    v_mov_b32_dpp v44, v42 row_newbcast:13 row_mask:0xf bank_mask:0xc
    v_and_b32 v48, v44, v12
    v_and_b32 v49, v44, v13
    v_and_b32 v50, v44, v14
    v_and_b32 v51, v44, v15
    s_waitcnt vmcnt(4)
    v_mfma_f32_16x16x32_bf16 v[16:19], v[84:87], v[52:55], v[16:19]
    buffer_load_dwordx4 v[72:75], v7, s[36:39], 0 offen offset:2048 nt
    v_mov_b32_dpp v45, v42 row_newbcast:14 row_mask:0xf bank_mask:0x3
    v_mov_b32_dpp v45, v42 row_newbcast:15 row_mask:0xf bank_mask:0xc
    v_and_b32 v52, v45, v12
    v_and_b32 v53, v45, v13
    v_and_b32 v54, v45, v14
    v_and_b32 v55, v45, v15
    s_waitcnt vmcnt(4)
    v_mfma_f32_16x16x32_bf16 v[16:19], v[88:91], v[48:51], v[16:19]
    buffer_load_dwordx4 v[76:79], v7, s[36:39], 0 offen offset:3072 nt
    s_nop 0
    s_waitcnt vmcnt(4)
    v_mfma_f32_16x16x32_bf16 v[16:19], v[92:95], v[52:55], v[16:19]
    buffer_load_dwordx4 v[80:83], v46, s[36:39], 0 offen offset:0 nt
    v_mov_b32 v5, v7
    v_mov_b32 v6, v46
    s_cmp_lt_u32 s58, 29
    s_cbranch_scc1 L_vtile
L_vdl:
    s_waitcnt lgkmcnt(0)
    s_add_u32 s58, s58, 1
    s_mov_b32 s59, 1
    s_atomic_add s59, s[64:65], 0 glc
    v_mov_b32 v40, v58
    v_cmp_lt_f32 vcc, v22, v40
    s_cbranch_vccnz L_rarel
L_backl:
    v_fma_f32 v41, v40, s60, -v21
    v_exp_f32 v41, v41
    s_nop 0
    v_add_f32 v20, v20, v41
    v_cvt_pk_bf16_f32 v42, v41, v41
    v_and_b32 v43, 0xffff0000, v42
    v_sub_f32 v43, v41, v43
    v_cvt_pk_bf16_f32 v43, v43, v43
    v_cndmask_b32 v42, v42, v43, s[54:55]
    s_nop 1
    v_mov_b32_dpp v44, v42 row_newbcast:0 row_mask:0xf bank_mask:0x3
    v_mov_b32_dpp v44, v42 row_newbcast:1 row_mask:0xf bank_mask:0xc
    v_and_b32 v48, v44, v12
    v_and_b32 v49, v44, v13
    v_and_b32 v50, v44, v14
    v_and_b32 v51, v44, v15
    v_mov_b32_dpp v45, v42 row_newbcast:2 row_mask:0xf bank_mask:0x3
    v_mov_b32_dpp v45, v42 row_newbcast:3 row_mask:0xf bank_mask:0xc
    v_and_b32 v52, v45, v12
    v_and_b32 v53, v45, v13
    v_and_b32 v54, v45, v14
    v_and_b32 v55, v45, v15
    s_waitcnt vmcnt(4)
    v_mfma_f32_16x16x32_bf16 v[16:19], v[64:67], v[48:51], v[16:19]
    buffer_load_dwordx4 v[84:87], v6, s[36:39], 0 offen offset:1024 nt
    v_mov_b32_dpp v44, v42 row_newbcast:4 row_mask:0xf bank_mask:0x3
    v_mov_b32_dpp v44, v42 row_newbcast:5 row_mask:0xf bank_mask:0xc
    v_and_b32 v48, v44, v12
    v_and_b32 v49, v44, v13
    v_and_b32 v50, v44, v14
    v_and_b32 v51, v44, v15
    s_waitcnt vmcnt(4)
    v_mfma_f32_16x16x32_bf16 v[16:19], v[68:71], v[52:55], v[16:19]
    buffer_load_dwordx4 v[88:91], v6, s[36:39], 0 offen offset:2048 nt
    v_mov_b32_dpp v45, v42 row_newbcast:6 row_mask:0xf bank_mask:0x3
    v_mov_b32_dpp v45, v42 row_newbcast:7 row_mask:0xf bank_mask:0xc
    v_and_b32 v52, v45, v12
    v_and_b32 v53, v45, v13
    v_and_b32 v54, v45, v14
    v_and_b32 v55, v45, v15
    s_waitcnt vmcnt(4)
    v_mfma_f32_16x16x32_bf16 v[16:19], v[72:75], v[48:51], v[16:19]
    buffer_load_dwordx4 v[92:95], v6, s[36:39], 0 offen offset:3072 nt
    v_mov_b32_dpp v44, v42 row_newbcast:8 row_mask:0xf bank_mask:0x3
    v_mov_b32_dpp v44, v42 row_newbcast:9 row_mask:0xf bank_mask:0xc
    v_and_b32 v48, v44, v12
    v_and_b32 v49, v44, v13
    v_and_b32 v50, v44, v14
    v_and_b32 v51, v44, v15
    s_waitcnt vmcnt(4)
    v_mfma_f32_16x16x32_bf16 v[16:19], v[76:79], v[52:55], v[16:19]
    s_waitcnt lgkmcnt(0)
    s_mov_b32 s91, s59
    s_bfe_u32 s30, s91, 0x30002
    s_lshl_b32 s30, s30, 7
    s_lshr_b32 s31, s91, 5
    s_lshl_b32 s31, s31, 2
    s_add_u32 s30, s30, s31
    s_and_b32 s31, s91, 3
    s_add_u32 s30, s30, s31
    s_add_u32 s30, s30, 120
    s_cmp_lt_u32 s91, 64
    s_cselect_b32 s62, s30, 1024
    s_lshl_b32 s63, s62, 13
    s_lshl_b32 s83, s91, 7
    s_add_u32 s83, s83, s84
    v_add_u32 v7, s63, v4
    v_add_u32 v46, 4096, v7
    s_cmp_ge_u32 s91, 48
    s_cbranch_scc1 L_fin
    buffer_load_dwordx2 v[60:61], v57, s[44:47], s83 offen sc1 nt
    buffer_load_dwordx4 v[64:67], v7, s[36:39], 0 offen offset:0 nt
    v_mov_b32_dpp v45, v42 row_newbcast:10 row_mask:0xf bank_mask:0x3
    v_mov_b32_dpp v45, v42 row_newbcast:11 row_mask:0xf bank_mask:0xc
    v_and_b32 v52, v45, v12
    v_and_b32 v53, v45, v13
    v_and_b32 v54, v45, v14
    v_and_b32 v55, v45, v15
    s_waitcnt vmcnt(5)
    v_mfma_f32_16x16x32_bf16 v[16:19], v[80:83], v[48:51], v[16:19]
    buffer_load_dwordx4 v[68:71], v7, s[36:39], 0 offen offset:1024 nt
    v_mov_b32_dpp v44, v42 row_newbcast:12 row_mask:0xf bank_mask:0x3
    v_mov_b32_dpp v44, v42 row_newbcast:13 row_mask:0xf bank_mask:0xc
    v_and_b32 v48, v44, v12
    v_and_b32 v49, v44, v13
    v_and_b32 v50, v44, v14
    v_and_b32 v51, v44, v15
    s_waitcnt vmcnt(5)
    v_mfma_f32_16x16x32_bf16 v[16:19], v[84:87], v[52:55], v[16:19]
    buffer_load_dwordx4 v[72:75], v7, s[36:39], 0 offen offset:2048 nt
    v_mov_b32_dpp v45, v42 row_newbcast:14 row_mask:0xf bank_mask:0x3
    v_mov_b32_dpp v45, v42 row_newbcast:15 row_mask:0xf bank_mask:0xc
    v_and_b32 v52, v45, v12
    v_and_b32 v53, v45, v13
    v_and_b32 v54, v45, v14
    v_and_b32 v55, v45, v15
    s_waitcnt vmcnt(5)
    v_mfma_f32_16x16x32_bf16 v[16:19], v[88:91], v[48:51], v[16:19]
    buffer_load_dwordx4 v[76:79], v7, s[36:39], 0 offen offset:3072 nt
    s_nop 0
    s_waitcnt vmcnt(5)
    v_mfma_f32_16x16x32_bf16 v[16:19], v[92:95], v[52:55], v[16:19]
    buffer_load_dwordx4 v[80:83], v46, s[36:39], 0 offen offset:0 nt
    s_mov_b32 s82, s83
    v_mov_b32 v5, v7
    v_mov_b32 v6, v46
    s_cmp_lt_u32 s62, 1024
    s_cbranch_scc0 L_vend
L_vda:
    s_waitcnt vmcnt(5)
    s_add_u32 s58, s58, 1
    s_mov_b32 s59, 1
    s_atomic_add s59, s[64:65], 0 glc
    v_lshlrev_b32 v40, v59, v60
    v_cmp_ne_u32 vcc, s6, v61
    v_and_b32 v40, 0xffff0000, v40
    s_cbranch_vccnz L_retrya
L_retry_backa:
    v_cmp_lt_f32 vcc, v22, v40
    s_cbranch_vccnz L_rarea
L_backa:
    v_fma_f32 v41, v40, s60, -v21
    v_exp_f32 v41, v41
    s_nop 0
    v_add_f32 v20, v20, v41
    v_cvt_pk_bf16_f32 v42, v41, v41
    v_and_b32 v43, 0xffff0000, v42
    v_sub_f32 v43, v41, v43
    v_cvt_pk_bf16_f32 v43, v43, v43
    v_cndmask_b32 v42, v42, v43, s[54:55]
    s_nop 1
    v_mov_b32_dpp v44, v42 row_newbcast:0 row_mask:0xf bank_mask:0x3
    v_mov_b32_dpp v44, v42 row_newbcast:1 row_mask:0xf bank_mask:0xc
    v_and_b32 v48, v44, v12
    v_and_b32 v49, v44, v13
    v_and_b32 v50, v44, v14
    v_and_b32 v51, v44, v15
    v_mov_b32_dpp v45, v42 row_newbcast:2 row_mask:0xf bank_mask:0x3
    v_mov_b32_dpp v45, v42 row_newbcast:3 row_mask:0xf bank_mask:0xc
    v_and_b32 v52, v45, v12
    v_and_b32 v53, v45, v13
    v_and_b32 v54, v45, v14
    v_and_b32 v55, v45, v15
    s_waitcnt vmcnt(4)
    v_mfma_f32_16x16x32_bf16 v[16:19], v[64:67], v[48:51], v[16:19]
    buffer_load_dwordx4 v[84:87], v6, s[36:39], 0 offen offset:1024 nt
    v_mov_b32_dpp v44, v42 row_newbcast:4 row_mask:0xf bank_mask:0x3
    v_mov_b32_dpp v44, v42 row_newbcast:5 row_mask:0xf bank_mask:0xc
    v_and_b32 v48, v44, v12
    v_and_b32 v49, v44, v13
    v_and_b32 v50, v44, v14
    v_and_b32 v51, v44, v15
    s_waitcnt vmcnt(4)
    v_mfma_f32_16x16x32_bf16 v[16:19], v[68:71], v[52:55], v[16:19]
    buffer_load_dwordx4 v[88:91], v6, s[36:39], 0 offen offset:2048 nt
    v_mov_b32_dpp v45, v42 row_newbcast:6 row_mask:0xf bank_mask:0x3
    v_mov_b32_dpp v45, v42 row_newbcast:7 row_mask:0xf bank_mask:0xc
    v_and_b32 v52, v45, v12
    v_and_b32 v53, v45, v13
    v_and_b32 v54, v45, v14
    v_and_b32 v55, v45, v15
    s_waitcnt vmcnt(4)
    v_mfma_f32_16x16x32_bf16 v[16:19], v[72:75], v[48:51], v[16:19]
    buffer_load_dwordx4 v[92:95], v6, s[36:39], 0 offen offset:3072 nt
    v_mov_b32_dpp v44, v42 row_newbcast:8 row_mask:0xf bank_mask:0x3
    v_mov_b32_dpp v44, v42 row_newbcast:9 row_mask:0xf bank_mask:0xc
    v_and_b32 v48, v44, v12
    v_and_b32 v49, v44, v13
    v_and_b32 v50, v44, v14
    v_and_b32 v51, v44, v15
    s_waitcnt vmcnt(4)
    v_mfma_f32_16x16x32_bf16 v[16:19], v[76:79], v[52:55], v[16:19]
    s_waitcnt lgkmcnt(0)
    s_mov_b32 s91, s59
    s_bfe_u32 s30, s91, 0x30002
    s_lshl_b32 s30, s30, 7
    s_lshr_b32 s31, s91, 5
    s_lshl_b32 s31, s31, 2
    s_add_u32 s30, s30, s31
    s_and_b32 s31, s91, 3
    s_add_u32 s30, s30, s31
    s_add_u32 s30, s30, 120
    s_cmp_lt_u32 s91, 64
    s_cselect_b32 s62, s30, 1024
    s_lshl_b32 s63, s62, 13
    s_lshl_b32 s83, s91, 7
    s_add_u32 s83, s83, s84
    v_add_u32 v7, s63, v4
    v_add_u32 v46, 4096, v7
    s_cmp_ge_u32 s91, 48
    s_cbranch_scc1 L_fin
    buffer_load_dwordx2 v[62:63], v57, s[44:47], s83 offen sc1 nt
    buffer_load_dwordx4 v[64:67], v7, s[36:39], 0 offen offset:0 nt
    v_mov_b32_dpp v45, v42 row_newbcast:10 row_mask:0xf bank_mask:0x3
    v_mov_b32_dpp v45, v42 row_newbcast:11 row_mask:0xf bank_mask:0xc
    v_and_b32 v52, v45, v12
    v_and_b32 v53, v45, v13
    v_and_b32 v54, v45, v14
    v_and_b32 v55, v45, v15
    s_waitcnt vmcnt(5)
    v_mfma_f32_16x16x32_bf16 v[16:19], v[80:83], v[48:51], v[16:19]
    buffer_load_dwordx4 v[68:71], v7, s[36:39], 0 offen offset:1024 nt
    v_mov_b32_dpp v44, v42 row_newbcast:12 row_mask:0xf bank_mask:0x3
    v_mov_b32_dpp v44, v42 row_newbcast:13 row_mask:0xf bank_mask:0xc
    v_and_b32 v48, v44, v12
    v_and_b32 v49, v44, v13
    v_and_b32 v50, v44, v14
    v_and_b32 v51, v44, v15
    s_waitcnt vmcnt(5)
    v_mfma_f32_16x16x32_bf16 v[16:19], v[84:87], v[52:55], v[16:19]
    buffer_load_dwordx4 v[72:75], v7, s[36:39], 0 offen offset:2048 nt
    v_mov_b32_dpp v45, v42 row_newbcast:14 row_mask:0xf bank_mask:0x3
    v_mov_b32_dpp v45, v42 row_newbcast:15 row_mask:0xf bank_mask:0xc
    v_and_b32 v52, v45, v12
    v_and_b32 v53, v45, v13
    v_and_b32 v54, v45, v14
    v_and_b32 v55, v45, v15
    s_waitcnt vmcnt(5)
    v_mfma_f32_16x16x32_bf16 v[16:19], v[88:91], v[48:51], v[16:19]
    buffer_load_dwordx4 v[76:79], v7, s[36:39], 0 offen offset:3072 nt
    s_nop 0
    s_waitcnt vmcnt(5)
    v_mfma_f32_16x16x32_bf16 v[16:19], v[92:95], v[52:55], v[16:19]
    buffer_load_dwordx4 v[80:83], v46, s[36:39], 0 offen offset:0 nt
    s_mov_b32 s82, s83
    v_mov_b32 v5, v7
    v_mov_b32 v6, v46
    s_cmp_lt_u32 s62, 1024
    s_cbranch_scc0 L_vend
L_vdb:
    s_waitcnt vmcnt(5)
    s_add_u32 s58, s58, 1
    s_mov_b32 s59, 1
    s_atomic_add s59, s[64:65], 0 glc
    v_lshlrev_b32 v40, v59, v62
    v_cmp_ne_u32 vcc, s6, v63
    v_and_b32 v40, 0xffff0000, v40
    s_cbranch_vccnz L_retryb
L_retry_backb:
    v_cmp_lt_f32 vcc, v22, v40
    s_cbranch_vccnz L_rareb
L_backb:
    v_fma_f32 v41, v40, s60, -v21
    v_exp_f32 v41, v41
    s_nop 0
    v_add_f32 v20, v20, v41
    v_cvt_pk_bf16_f32 v42, v41, v41
    v_and_b32 v43, 0xffff0000, v42
    v_sub_f32 v43, v41, v43
    v_cvt_pk_bf16_f32 v43, v43, v43
    v_cndmask_b32 v42, v42, v43, s[54:55]
    s_nop 1
    v_mov_b32_dpp v44, v42 row_newbcast:0 row_mask:0xf bank_mask:0x3
    v_mov_b32_dpp v44, v42 row_newbcast:1 row_mask:0xf bank_mask:0xc
    v_and_b32 v48, v44, v12
    v_and_b32 v49, v44, v13
    v_and_b32 v50, v44, v14
    v_and_b32 v51, v44, v15
    v_mov_b32_dpp v45, v42 row_newbcast:2 row_mask:0xf bank_mask:0x3
    v_mov_b32_dpp v45, v42 row_newbcast:3 row_mask:0xf bank_mask:0xc
    v_and_b32 v52, v45, v12
    v_and_b32 v53, v45, v13
    v_and_b32 v54, v45, v14
    v_and_b32 v55, v45, v15
    s_waitcnt vmcnt(4)
    v_mfma_f32_16x16x32_bf16 v[16:19], v[64:67], v[48:51], v[16:19]
    buffer_load_dwordx4 v[84:87], v6, s[36:39], 0 offen offset:1024 nt
    v_mov_b32_dpp v44, v42 row_newbcast:4 row_mask:0xf bank_mask:0x3
    v_mov_b32_dpp v44, v42 row_newbcast:5 row_mask:0xf bank_mask:0xc
    v_and_b32 v48, v44, v12
    v_and_b32 v49, v44, v13
    v_and_b32 v50, v44, v14
    v_and_b32 v51, v44, v15
    s_waitcnt vmcnt(4)
    v_mfma_f32_16x16x32_bf16 v[16:19], v[68:71], v[52:55], v[16:19]
    buffer_load_dwordx4 v[88:91], v6, s[36:39], 0 offen offset:2048 nt
    v_mov_b32_dpp v45, v42 row_newbcast:6 row_mask:0xf bank_mask:0x3
    v_mov_b32_dpp v45, v42 row_newbcast:7 row_mask:0xf bank_mask:0xc
    v_and_b32 v52, v45, v12
    v_and_b32 v53, v45, v13
    v_and_b32 v54, v45, v14
    v_and_b32 v55, v45, v15
    s_waitcnt vmcnt(4)
    v_mfma_f32_16x16x32_bf16 v[16:19], v[72:75], v[48:51], v[16:19]
    buffer_load_dwordx4 v[92:95], v6, s[36:39], 0 offen offset:3072 nt
    v_mov_b32_dpp v44, v42 row_newbcast:8 row_mask:0xf bank_mask:0x3
    v_mov_b32_dpp v44, v42 row_newbcast:9 row_mask:0xf bank_mask:0xc
    v_and_b32 v48, v44, v12
    v_and_b32 v49, v44, v13
    v_and_b32 v50, v44, v14
    v_and_b32 v51, v44, v15
    s_waitcnt vmcnt(4)
    v_mfma_f32_16x16x32_bf16 v[16:19], v[76:79], v[52:55], v[16:19]
    s_waitcnt lgkmcnt(0)
    s_mov_b32 s91, s59
    s_bfe_u32 s30, s91, 0x30002
    s_lshl_b32 s30, s30, 7
    s_lshr_b32 s31, s91, 5
    s_lshl_b32 s31, s31, 2
    s_add_u32 s30, s30, s31
    s_and_b32 s31, s91, 3
    s_add_u32 s30, s30, s31
    s_add_u32 s30, s30, 120
    s_cmp_lt_u32 s91, 64
    s_cselect_b32 s62, s30, 1024
    s_lshl_b32 s63, s62, 13
    s_lshl_b32 s83, s91, 7
    s_add_u32 s83, s83, s84
    v_add_u32 v7, s63, v4
    v_add_u32 v46, 4096, v7
    s_cmp_ge_u32 s91, 48
    s_cbranch_scc1 L_fin
    buffer_load_dwordx2 v[60:61], v57, s[44:47], s83 offen sc1 nt
    buffer_load_dwordx4 v[64:67], v7, s[36:39], 0 offen offset:0 nt
    v_mov_b32_dpp v45, v42 row_newbcast:10 row_mask:0xf bank_mask:0x3
    v_mov_b32_dpp v45, v42 row_newbcast:11 row_mask:0xf bank_mask:0xc
    v_and_b32 v52, v45, v12
    v_and_b32 v53, v45, v13
    v_and_b32 v54, v45, v14
    v_and_b32 v55, v45, v15
    s_waitcnt vmcnt(5)
    v_mfma_f32_16x16x32_bf16 v[16:19], v[80:83], v[48:51], v[16:19]
    buffer_load_dwordx4 v[68:71], v7, s[36:39], 0 offen offset:1024 nt
    v_mov_b32_dpp v44, v42 row_newbcast:12 row_mask:0xf bank_mask:0x3
    v_mov_b32_dpp v44, v42 row_newbcast:13 row_mask:0xf bank_mask:0xc
    v_and_b32 v48, v44, v12
    v_and_b32 v49, v44, v13
    v_and_b32 v50, v44, v14
    v_and_b32 v51, v44, v15
    s_waitcnt vmcnt(5)
    v_mfma_f32_16x16x32_bf16 v[16:19], v[84:87], v[52:55], v[16:19]
    buffer_load_dwordx4 v[72:75], v7, s[36:39], 0 offen offset:2048 nt
    v_mov_b32_dpp v45, v42 row_newbcast:14 row_mask:0xf bank_mask:0x3
    v_mov_b32_dpp v45, v42 row_newbcast:15 row_mask:0xf bank_mask:0xc
    v_and_b32 v52, v45, v12
    v_and_b32 v53, v45, v13
    v_and_b32 v54, v45, v14
    v_and_b32 v55, v45, v15
    s_waitcnt vmcnt(5)
    v_mfma_f32_16x16x32_bf16 v[16:19], v[88:91], v[48:51], v[16:19]
    buffer_load_dwordx4 v[76:79], v7, s[36:39], 0 offen offset:3072 nt
    s_nop 0
    s_waitcnt vmcnt(5)
    v_mfma_f32_16x16x32_bf16 v[16:19], v[92:95], v[52:55], v[16:19]
    buffer_load_dwordx4 v[80:83], v46, s[36:39], 0 offen offset:0 nt
    s_mov_b32 s82, s83
    v_mov_b32 v5, v7
    v_mov_b32 v6, v46
    s_cmp_lt_u32 s62, 1024
    s_cbranch_scc1 L_vda
    s_branch L_vend
L_fin:
    buffer_load_dwordx2 v[130:131], v57, s[44:47], s83 offen sc1 nt
    buffer_load_dwordx4 v[96:99], v7, s[36:39], 0 offen offset:0 nt
    buffer_load_dwordx4 v[100:103], v7, s[36:39], 0 offen offset:1024 nt
    buffer_load_dwordx4 v[104:107], v7, s[36:39], 0 offen offset:2048 nt
    buffer_load_dwordx4 v[108:111], v7, s[36:39], 0 offen offset:3072 nt
    buffer_load_dwordx4 v[112:115], v46, s[36:39], 0 offen offset:0 nt
    buffer_load_dwordx4 v[116:119], v46, s[36:39], 0 offen offset:1024 nt
    buffer_load_dwordx4 v[120:123], v46, s[36:39], 0 offen offset:2048 nt
    buffer_load_dwordx4 v[124:127], v46, s[36:39], 0 offen offset:3072 nt
    v_mov_b32_dpp v45, v42 row_newbcast:10 row_mask:0xf bank_mask:0x3
    v_mov_b32_dpp v45, v42 row_newbcast:11 row_mask:0xf bank_mask:0xc
    v_and_b32 v52, v45, v12
    v_and_b32 v53, v45, v13
    v_and_b32 v54, v45, v14
    v_and_b32 v55, v45, v15
    s_waitcnt vmcnt(12)
    v_mfma_f32_16x16x32_bf16 v[16:19], v[80:83], v[48:51], v[16:19]
    v_mov_b32_dpp v44, v42 row_newbcast:12 row_mask:0xf bank_mask:0x3
    v_mov_b32_dpp v44, v42 row_newbcast:13 row_mask:0xf bank_mask:0xc
    v_and_b32 v48, v44, v12
    v_and_b32 v49, v44, v13
    v_and_b32 v50, v44, v14
    v_and_b32 v51, v44, v15
    s_waitcnt vmcnt(11)
    v_mfma_f32_16x16x32_bf16 v[16:19], v[84:87], v[52:55], v[16:19]
    v_mov_b32_dpp v45, v42 row_newbcast:14 row_mask:0xf bank_mask:0x3
    v_mov_b32_dpp v45, v42 row_newbcast:15 row_mask:0xf bank_mask:0xc
    v_and_b32 v52, v45, v12
    v_and_b32 v53, v45, v13
    v_and_b32 v54, v45, v14
    v_and_b32 v55, v45, v15
    s_waitcnt vmcnt(10)
    v_mfma_f32_16x16x32_bf16 v[16:19], v[88:91], v[48:51], v[16:19]
    s_nop 0
    s_waitcnt vmcnt(9)
    v_mfma_f32_16x16x32_bf16 v[16:19], v[92:95], v[52:55], v[16:19]
    s_cmp_lt_u32 s62, 1024
    s_cbranch_scc0 L_vend
    s_mov_b32 s82, s83
    s_waitcnt vmcnt(8)
    s_add_u32 s58, s58, 1
    v_lshlrev_b32 v40, v59, v130
    v_cmp_ne_u32 vcc, s6, v131
    v_and_b32 v40, 0xffff0000, v40
    s_cbranch_vccnz L_retryf
L_retry_backf:
    v_cmp_lt_f32 vcc, v22, v40
    s_cbranch_vccnz L_raref
L_backf:
    v_fma_f32 v41, v40, s60, -v21
    v_exp_f32 v41, v41
    s_nop 0
    v_add_f32 v20, v20, v41
    v_cvt_pk_bf16_f32 v42, v41, v41
    v_and_b32 v43, 0xffff0000, v42
    v_sub_f32 v43, v41, v43
    v_cvt_pk_bf16_f32 v43, v43, v43
    v_cndmask_b32 v42, v42, v43, s[54:55]
    s_nop 1
    v_mov_b32_dpp v44, v42 row_newbcast:0 row_mask:0xf bank_mask:0x3
    v_mov_b32_dpp v44, v42 row_newbcast:1 row_mask:0xf bank_mask:0xc
    v_and_b32 v48, v44, v12
    v_and_b32 v49, v44, v13
    v_and_b32 v50, v44, v14
    v_and_b32 v51, v44, v15
    v_mov_b32_dpp v45, v42 row_newbcast:2 row_mask:0xf bank_mask:0x3
    v_mov_b32_dpp v45, v42 row_newbcast:3 row_mask:0xf bank_mask:0xc
    v_and_b32 v52, v45, v12
    v_and_b32 v53, v45, v13
    v_and_b32 v54, v45, v14
    v_and_b32 v55, v45, v15
    s_waitcnt vmcnt(7)
    v_mfma_f32_16x16x32_bf16 v[16:19], v[96:99], v[48:51], v[16:19]
    v_mov_b32_dpp v44, v42 row_newbcast:4 row_mask:0xf bank_mask:0x3
    v_mov_b32_dpp v44, v42 row_newbcast:5 row_mask:0xf bank_mask:0xc
    v_and_b32 v48, v44, v12
    v_and_b32 v49, v44, v13
    v_and_b32 v50, v44, v14
    v_and_b32 v51, v44, v15
    s_waitcnt vmcnt(6)
    v_mfma_f32_16x16x32_bf16 v[16:19], v[100:103], v[52:55], v[16:19]
    v_mov_b32_dpp v45, v42 row_newbcast:6 row_mask:0xf bank_mask:0x3
    v_mov_b32_dpp v45, v42 row_newbcast:7 row_mask:0xf bank_mask:0xc
    v_and_b32 v52, v45, v12
    v_and_b32 v53, v45, v13
    v_and_b32 v54, v45, v14
    v_and_b32 v55, v45, v15
    s_waitcnt vmcnt(5)
    v_mfma_f32_16x16x32_bf16 v[16:19], v[104:107], v[48:51], v[16:19]
    v_mov_b32_dpp v44, v42 row_newbcast:8 row_mask:0xf bank_mask:0x3
    v_mov_b32_dpp v44, v42 row_newbcast:9 row_mask:0xf bank_mask:0xc
    v_and_b32 v48, v44, v12
    v_and_b32 v49, v44, v13
    v_and_b32 v50, v44, v14
    v_and_b32 v51, v44, v15
    s_waitcnt vmcnt(4)
    v_mfma_f32_16x16x32_bf16 v[16:19], v[108:111], v[52:55], v[16:19]
    v_mov_b32_dpp v45, v42 row_newbcast:10 row_mask:0xf bank_mask:0x3
    v_mov_b32_dpp v45, v42 row_newbcast:11 row_mask:0xf bank_mask:0xc
    v_and_b32 v52, v45, v12
    v_and_b32 v53, v45, v13
    v_and_b32 v54, v45, v14
    v_and_b32 v55, v45, v15
    s_waitcnt vmcnt(3)
    v_mfma_f32_16x16x32_bf16 v[16:19], v[112:115], v[48:51], v[16:19]
    v_mov_b32_dpp v44, v42 row_newbcast:12 row_mask:0xf bank_mask:0x3
    v_mov_b32_dpp v44, v42 row_newbcast:13 row_mask:0xf bank_mask:0xc
    v_and_b32 v48, v44, v12
    v_and_b32 v49, v44, v13
    v_and_b32 v50, v44, v14
    v_and_b32 v51, v44, v15
    s_waitcnt vmcnt(2)
    v_mfma_f32_16x16x32_bf16 v[16:19], v[116:119], v[52:55], v[16:19]
    v_mov_b32_dpp v45, v42 row_newbcast:14 row_mask:0xf bank_mask:0x3
    v_mov_b32_dpp v45, v42 row_newbcast:15 row_mask:0xf bank_mask:0xc
    v_and_b32 v52, v45, v12
    v_and_b32 v53, v45, v13
    v_and_b32 v54, v45, v14
    v_and_b32 v55, v45, v15
    s_waitcnt vmcnt(1)
    v_mfma_f32_16x16x32_bf16 v[16:19], v[120:123], v[48:51], v[16:19]
    s_nop 0
    s_waitcnt vmcnt(0)
    v_mfma_f32_16x16x32_bf16 v[16:19], v[124:127], v[52:55], v[16:19]
    s_nop 3
    s_branch L_vend
L_vend:
    s_nop 1
    v_add_f32_dpp v20, v20, v20 row_ror:8 row_mask:0xf bank_mask:0xf
    s_nop 1
    v_add_f32_dpp v20, v20, v20 row_ror:4 row_mask:0xf bank_mask:0xf
    s_nop 1
    v_add_f32_dpp v20, v20, v20 row_ror:2 row_mask:0xf bank_mask:0xf
    s_nop 1
    v_add_f32_dpp v20, v20, v20 row_ror:1 row_mask:0xf bank_mask:0xf
    v_mov_b32 v27, v20
    s_nop 1
    v_permlane16_swap_b32 v20, v27
    v_add_f32 v20, v20, v27
    v_mov_b32 v27, v20
    s_nop 1
    v_permlane32_swap_b32 v20, v27
    v_add_f32 v20, v20, v27
    v_mul_f32 v23, 0.5, v20
    v_add_f32_dpp v16, v16, v16 row_ror:8 row_mask:0xf bank_mask:0xf
    v_add_f32_dpp v17, v17, v17 row_ror:8 row_mask:0xf bank_mask:0xf
    v_add_f32_dpp v18, v18, v18 row_ror:8 row_mask:0xf bank_mask:0xf
    v_add_f32_dpp v19, v19, v19 row_ror:8 row_mask:0xf bank_mask:0xf
    s_mov_b32 s52, 0xff00ff00
    s_mov_b32 s53, 0xff00ff00
    v_lshl_add_u32 v26, v2, 5, v3
    v_lshlrev_b32 v26, 2, v26
    s_lshl_b32 s30, s3, 9
    v_add_u32 v26, s30, v26
    v_cndmask_b32 v24, v16, v17, s[52:53]
    v_cndmask_b32 v25, v18, v19, s[52:53]
    s_lshl_b32 s30, s3, 3
    v_mov_b32 v27, s30
    ds_write_b32 v26, v24 offset:512
    ds_write_b32 v26, v25 offset:576
    s_mov_b64 exec, 1
    ds_write_b64 v27, v[22:23] offset:256
    s_mov_b64 exec, -1
    s_waitcnt lgkmcnt(0)
    s_barrier
    s_endpgm
L_rares:
    v_mov_b32 v41, v40
    s_nop 1
    v_max_f32_dpp v41, v41, v41 row_ror:8 row_mask:0xf bank_mask:0xf
    s_nop 1
    v_max_f32_dpp v41, v41, v41 row_ror:4 row_mask:0xf bank_mask:0xf
    s_nop 1
    v_max_f32_dpp v41, v41, v41 row_ror:2 row_mask:0xf bank_mask:0xf
    s_nop 1
    v_max_f32_dpp v41, v41, v41 row_bcast:15 row_mask:0xa bank_mask:0xf
    s_nop 1
    v_max_f32_dpp v41, v41, v41 row_bcast:31 row_mask:0xc bank_mask:0xf
    s_nop 0
    v_readlane_b32 s30, v41, 63
    s_nop 1
    v_mov_b32 v22, s30
    v_mul_f32 v42, s60, v22
    v_sub_f32 v43, v21, v42
    v_exp_f32 v43, v43
    v_mov_b32 v21, v42
    v_mul_f32 v16, v16, v43
    v_mul_f32 v17, v17, v43
    v_mul_f32 v18, v18, v43
    v_mul_f32 v19, v19, v43
    v_mul_f32 v20, v20, v43
    s_branch L_backs
L_rarel:
    v_mov_b32 v41, v40
    s_nop 1
    v_max_f32_dpp v41, v41, v41 row_ror:8 row_mask:0xf bank_mask:0xf
    s_nop 1
    v_max_f32_dpp v41, v41, v41 row_ror:4 row_mask:0xf bank_mask:0xf
    s_nop 1
    v_max_f32_dpp v41, v41, v41 row_ror:2 row_mask:0xf bank_mask:0xf
    s_nop 1
    v_max_f32_dpp v41, v41, v41 row_bcast:15 row_mask:0xa bank_mask:0xf
    s_nop 1
    v_max_f32_dpp v41, v41, v41 row_bcast:31 row_mask:0xc bank_mask:0xf
    s_nop 0
    v_readlane_b32 s30, v41, 63
    s_nop 1
    v_mov_b32 v22, s30
    v_mul_f32 v42, s60, v22
    v_sub_f32 v43, v21, v42
    v_exp_f32 v43, v43
    v_mov_b32 v21, v42
    v_mul_f32 v16, v16, v43
    v_mul_f32 v17, v17, v43
    v_mul_f32 v18, v18, v43
    v_mul_f32 v19, v19, v43
    v_mul_f32 v20, v20, v43
    s_branch L_backl
L_rarea:
    v_mov_b32 v41, v40
    s_nop 1
    v_max_f32_dpp v41, v41, v41 row_ror:8 row_mask:0xf bank_mask:0xf
    s_nop 1
    v_max_f32_dpp v41, v41, v41 row_ror:4 row_mask:0xf bank_mask:0xf
    s_nop 1
    v_max_f32_dpp v41, v41, v41 row_ror:2 row_mask:0xf bank_mask:0xf
    s_nop 1
    v_max_f32_dpp v41, v41, v41 row_bcast:15 row_mask:0xa bank_mask:0xf
    s_nop 1
    v_max_f32_dpp v41, v41, v41 row_bcast:31 row_mask:0xc bank_mask:0xf
    s_nop 0
    v_readlane_b32 s30, v41, 63
    s_nop 1
    v_mov_b32 v22, s30
    v_mul_f32 v42, s60, v22
    v_sub_f32 v43, v21, v42
    v_exp_f32 v43, v43
    v_mov_b32 v21, v42
    v_mul_f32 v16, v16, v43
    v_mul_f32 v17, v17, v43
    v_mul_f32 v18, v18, v43
    v_mul_f32 v19, v19, v43
    v_mul_f32 v20, v20, v43
    s_branch L_backa
L_rareb:
    v_mov_b32 v41, v40
    s_nop 1
    v_max_f32_dpp v41, v41, v41 row_ror:8 row_mask:0xf bank_mask:0xf
    s_nop 1
    v_max_f32_dpp v41, v41, v41 row_ror:4 row_mask:0xf bank_mask:0xf
    s_nop 1
    v_max_f32_dpp v41, v41, v41 row_ror:2 row_mask:0xf bank_mask:0xf
    s_nop 1
    v_max_f32_dpp v41, v41, v41 row_bcast:15 row_mask:0xa bank_mask:0xf
    s_nop 1
    v_max_f32_dpp v41, v41, v41 row_bcast:31 row_mask:0xc bank_mask:0xf
    s_nop 0
    v_readlane_b32 s30, v41, 63
    s_nop 1
    v_mov_b32 v22, s30
    v_mul_f32 v42, s60, v22
    v_sub_f32 v43, v21, v42
    v_exp_f32 v43, v43
    v_mov_b32 v21, v42
    v_mul_f32 v16, v16, v43
    v_mul_f32 v17, v17, v43
    v_mul_f32 v18, v18, v43
    v_mul_f32 v19, v19, v43
    v_mul_f32 v20, v20, v43
    s_branch L_backb
L_raref:
    v_mov_b32 v41, v40
    s_nop 1
    v_max_f32_dpp v41, v41, v41 row_ror:8 row_mask:0xf bank_mask:0xf
    s_nop 1
    v_max_f32_dpp v41, v41, v41 row_ror:4 row_mask:0xf bank_mask:0xf
    s_nop 1
    v_max_f32_dpp v41, v41, v41 row_ror:2 row_mask:0xf bank_mask:0xf
    s_nop 1
    v_max_f32_dpp v41, v41, v41 row_bcast:15 row_mask:0xa bank_mask:0xf
    s_nop 1
    v_max_f32_dpp v41, v41, v41 row_bcast:31 row_mask:0xc bank_mask:0xf
    s_nop 0
    v_readlane_b32 s30, v41, 63
    s_nop 1
    v_mov_b32 v22, s30
    v_mul_f32 v42, s60, v22
    v_sub_f32 v43, v21, v42
    v_exp_f32 v43, v43
    v_mov_b32 v21, v42
    v_mul_f32 v16, v16, v43
    v_mul_f32 v17, v17, v43
    v_mul_f32 v18, v18, v43
    v_mul_f32 v19, v19, v43
    v_mul_f32 v20, v20, v43
    s_branch L_backf
L_retrya:
    s_mov_b32 s49, 0
L_retry_loopa:
    buffer_load_dwordx2 v[60:61], v57, s[44:47], s82 offen sc1
    s_waitcnt vmcnt(0)
    v_cmp_ne_u32 vcc, s6, v61
    s_cbranch_vccz L_retry_donea
    s_add_u32 s49, s49, 1
    s_sleep 2
    s_cmp_lt_u32 s49, 40000
    s_cbranch_scc1 L_retry_loopa
L_retry_donea:
    v_lshlrev_b32 v40, v59, v60
    v_and_b32 v40, 0xffff0000, v40
    s_branch L_retry_backa
L_retryb:
    s_mov_b32 s49, 0
L_retry_loopb:
    buffer_load_dwordx2 v[62:63], v57, s[44:47], s82 offen sc1
    s_waitcnt vmcnt(0)
    v_cmp_ne_u32 vcc, s6, v63
    s_cbranch_vccz L_retry_doneb
    s_add_u32 s49, s49, 1
    s_sleep 2
    s_cmp_lt_u32 s49, 40000
    s_cbranch_scc1 L_retry_loopb
L_retry_doneb:
    v_lshlrev_b32 v40, v59, v62
    v_and_b32 v40, 0xffff0000, v40
    s_branch L_retry_backb
L_retryf:
    s_mov_b32 s49, 0
L_retry_loopf:
    buffer_load_dwordx2 v[130:131], v57, s[44:47], s82 offen sc1
    s_waitcnt vmcnt(0)
    v_cmp_ne_u32 vcc, s6, v131
    s_cbranch_vccz L_retry_donef
    s_add_u32 s49, s49, 1
    s_sleep 2
    s_cmp_lt_u32 s49, 40000
    s_cbranch_scc1 L_retry_loopf
L_retry_donef:
    v_lshlrev_b32 v40, v59, v130
    v_and_b32 v40, 0xffff0000, v40
    s_branch L_retry_backf
L_helperA:

    s_cmp_eq_u32 s5, 0
    s_cbranch_scc0 L_nozero
    s_mul_i32 s30, s4, 256
    s_add_u32 s30, s30, 4096
    v_mul_u32_u24 v4, 128, v0
    v_add_u32 v4, s30, v4
    v_mov_b32 v5, 0
    s_mov_b64 exec, 3
    buffer_store_dword v5, v4, s[44:47], 0 offen sc1
    s_mov_b64 exec, -1
L_nozero:

    s_mul_i32 s48, s5, 72

    s_mov_b32 s32, s8
    s_mov_b32 s33, s9
    s_mov_b32 s34, 1152
    s_mov_b32 s35, 0x20000
    v_lshlrev_b32 v20, 3, v0
    v_lshlrev_b32 v21, 1, v0
    v_lshl_add_u32 v22, v3, 2, v2
    v_add_u32 v22, s48, v22
    v_lshlrev_b32 v22, 1, v22
    buffer_load_dwordx2 v[4:5], v20, s[32:35], 0 offen
    buffer_load_dwordx2 v[6:7], v20, s[32:35], 0 offen offset:512
    buffer_load_ushort v8, v21, s[32:35], 0 offen offset:1024
    buffer_load_ushort v9, v22, s[32:35], 0 offen
    buffer_load_ushort v10, v22, s[32:35], 0 offen offset:128

    s_mov_b32 s36, s14
    s_mov_b32 s37, s15
    s_mov_b32 s38, 4718592
    s_mov_b32 s39, 0x20000
    v_add_u32 v23, s48, v2
    v_lshlrev_b32 v23, 13, v23
    v_lshl_add_u32 v23, v3, 4, v23
    s_lshl_b32 s30, s4, 8
    v_add_u32 v23, s30, v23

    s_mov_b32 s31, 0
    buffer_load_dwordx4 v[64:67], v23, s[36:39], s31 offen nt
    s_mov_b32 s31, 32768
    buffer_load_dwordx4 v[68:71], v23, s[36:39], s31 offen nt
    s_mov_b32 s31, 65536
    buffer_load_dwordx4 v[72:75], v23, s[36:39], s31 offen nt
    s_mov_b32 s31, 98304
    buffer_load_dwordx4 v[76:79], v23, s[36:39], s31 offen nt
    s_mov_b32 s31, 131072
    buffer_load_dwordx4 v[80:83], v23, s[36:39], s31 offen nt
    s_mov_b32 s31, 163840
    buffer_load_dwordx4 v[84:87], v23, s[36:39], s31 offen nt
    s_mov_b32 s31, 196608
    buffer_load_dwordx4 v[88:91], v23, s[36:39], s31 offen nt
    s_mov_b32 s31, 229376
    buffer_load_dwordx4 v[92:95], v23, s[36:39], s31 offen nt
    s_mov_b32 s31, 262144
    buffer_load_dwordx4 v[96:99], v23, s[36:39], s31 offen nt
    s_mov_b32 s31, 294912
    buffer_load_dwordx4 v[100:103], v23, s[36:39], s31 offen nt
    s_mov_b32 s31, 327680
    buffer_load_dwordx4 v[104:107], v23, s[36:39], s31 offen nt
    s_mov_b32 s31, 360448
    buffer_load_dwordx4 v[108:111], v23, s[36:39], s31 offen nt
    s_mov_b32 s31, 393216
    buffer_load_dwordx4 v[112:115], v23, s[36:39], s31 offen nt
    s_mov_b32 s31, 425984
    buffer_load_dwordx4 v[116:119], v23, s[36:39], s31 offen nt
    s_mov_b32 s31, 458752
    buffer_load_dwordx4 v[120:123], v23, s[36:39], s31 offen nt
    s_mov_b32 s31, 491520
    buffer_load_dwordx4 v[124:127], v23, s[36:39], s31 offen nt
    s_mov_b32 s31, 524288
    buffer_load_dwordx4 v[128:131], v23, s[36:39], s31 offen nt
    s_mov_b32 s31, 557056
    buffer_load_dwordx4 v[132:135], v23, s[36:39], s31 offen nt
    s_barrier
    v_and_b32 v20, 7, v3
    v_and_b32 v21, 1, v3
    v_lshlrev_b32 v21, 4, v21
    v_mov_b32 v12, 0xffff
    v_lshlrev_b32 v21, v21, v12
    v_lshrrev_b32 v20, 1, v20
    v_cmp_eq_u32 vcc, 0, v20
    s_nop 1
    v_cndmask_b32 v12, 0, v21, vcc
    v_cmp_eq_u32 vcc, 1, v20
    s_nop 1
    v_cndmask_b32 v13, 0, v21, vcc
    v_cmp_eq_u32 vcc, 2, v20
    s_nop 1
    v_cndmask_b32 v14, 0, v21, vcc
    v_cmp_eq_u32 vcc, 3, v20
    s_nop 1
    v_cndmask_b32 v15, 0, v21, vcc
    s_waitcnt vmcnt(18)
    v_lshlrev_b32 v24, 16, v4
    v_and_b32 v25, 0xffff0000, v4
    v_lshlrev_b32 v26, 16, v5
    v_and_b32 v27, 0xffff0000, v5
    v_lshlrev_b32 v28, 16, v6
    v_and_b32 v29, 0xffff0000, v6
    v_lshlrev_b32 v30, 16, v7
    v_and_b32 v31, 0xffff0000, v7
    v_lshlrev_b32 v32, 16, v8
    v_add_f32 v33, v24, v25
    v_add_f32 v34, v26, v27
    v_add_f32 v35, v28, v29
    v_add_f32 v36, v30, v31
    v_add_f32 v33, v33, v34
    v_add_f32 v35, v35, v36
    v_add_f32 v33, v33, v32
    v_add_f32 v33, v33, v35
    s_nop 1
    v_add_f32_dpp v33, v33, v33 row_ror:8 row_mask:0xf bank_mask:0xf
    s_nop 1
    v_add_f32_dpp v33, v33, v33 row_ror:4 row_mask:0xf bank_mask:0xf
    s_nop 1
    v_add_f32_dpp v33, v33, v33 row_ror:2 row_mask:0xf bank_mask:0xf
    s_nop 1
    v_add_f32_dpp v33, v33, v33 row_ror:1 row_mask:0xf bank_mask:0xf
    v_mov_b32 v34, v33
    s_nop 1
    v_permlane16_swap_b32 v33, v34
    v_add_f32 v33, v33, v34
    v_mov_b32 v34, v33
    s_nop 1
    v_permlane32_swap_b32 v33, v34
    v_add_f32 v33, v33, v34
    v_mov_b32 v36, 0x44100000
    v_mov_b32 v37, 0x3ae38e39
    v_mul_f32 v38, v33, v37
    v_fma_f32 v34, -v38, v36, v33
    v_fma_f32 v38, v34, v37, v38
    v_sub_f32 v24, v24, v38
    v_sub_f32 v25, v25, v38
    v_sub_f32 v26, v26, v38
    v_sub_f32 v27, v27, v38
    v_sub_f32 v28, v28, v38
    v_sub_f32 v29, v29, v38
    v_sub_f32 v30, v30, v38
    v_sub_f32 v31, v31, v38
    v_sub_f32 v32, v32, v38
    v_mul_f32 v33, v24, v24
    v_fmac_f32 v33, v25, v25
    v_fmac_f32 v33, v26, v26
    v_fmac_f32 v33, v27, v27
    v_fmac_f32 v33, v28, v28
    v_fmac_f32 v33, v29, v29
    v_fmac_f32 v33, v30, v30
    v_fmac_f32 v33, v31, v31
    v_fmac_f32 v33, v32, v32
    s_nop 1
    v_add_f32_dpp v33, v33, v33 row_ror:8 row_mask:0xf bank_mask:0xf
    s_nop 1
    v_add_f32_dpp v33, v33, v33 row_ror:4 row_mask:0xf bank_mask:0xf
    s_nop 1
    v_add_f32_dpp v33, v33, v33 row_ror:2 row_mask:0xf bank_mask:0xf
    s_nop 1
    v_add_f32_dpp v33, v33, v33 row_ror:1 row_mask:0xf bank_mask:0xf
    v_mov_b32 v34, v33
    s_nop 1
    v_permlane16_swap_b32 v33, v34
    v_add_f32 v33, v33, v34
    v_mov_b32 v34, v33
    s_nop 1
    v_permlane32_swap_b32 v33, v34
    v_add_f32 v33, v33, v34
    v_mul_f32 v39, v33, v37
    v_fma_f32 v34, -v39, v36, v33
    v_fma_f32 v39, v34, v37, v39
    v_cvt_pk_bf16_f32 v38, v38, v38
    v_and_b32 v38, 0xffff0000, v38
    v_cvt_pk_bf16_f32 v39, v39, v39
    v_and_b32 v39, 0xffff0000, v39
    v_add_f32 v39, 0x3727c5ac, v39
    v_cvt_pk_bf16_f32 v39, v39, v39
    v_and_b32 v39, 0xffff0000, v39
    v_sqrt_f32 v39, v39
    s_nop 0
    v_cvt_pk_bf16_f32 v39, v39, v39
    v_and_b32 v39, 0xffff0000, v39
    v_rcp_f32 v37, v39
    v_lshlrev_b32 v9, 16, v9
    v_sub_f32 v9, v9, v38
    v_cvt_pk_bf16_f32 v9, v9, v9
    v_and_b32 v9, 0xffff0000, v9
    v_lshlrev_b32 v10, 16, v10
    v_sub_f32 v10, v10, v38
    v_cvt_pk_bf16_f32 v10, v10, v10
    v_and_b32 v10, 0xffff0000, v10
    v_mul_f32 v33, v9, v37
    v_fma_f32 v34, -v33, v39, v9
    v_fma_f32 v33, v34, v37, v33
    v_cvt_pk_bf16_f32 v9, v33, v33
    v_mul_f32 v33, v10, v37
    v_fma_f32 v34, -v33, v39, v10
    v_fma_f32 v33, v34, v37, v33
    v_cvt_pk_bf16_f32 v10, v33, v33
    v_mov_b32 v16, 0
    v_mov_b32 v17, 0
    v_mov_b32 v18, 0
    v_mov_b32 v19, 0
    s_nop 1
    v_and_b32_dpp v24, v9, v12 row_newbcast:0 row_mask:0xf bank_mask:0xf
    v_and_b32_dpp v25, v9, v13 row_newbcast:0 row_mask:0xf bank_mask:0xf
    v_and_b32_dpp v26, v9, v14 row_newbcast:0 row_mask:0xf bank_mask:0xf
    v_and_b32_dpp v27, v9, v15 row_newbcast:0 row_mask:0xf bank_mask:0xf
    v_and_b32_dpp v28, v9, v12 row_newbcast:1 row_mask:0xf bank_mask:0xf
    v_and_b32_dpp v29, v9, v13 row_newbcast:1 row_mask:0xf bank_mask:0xf
    v_and_b32_dpp v30, v9, v14 row_newbcast:1 row_mask:0xf bank_mask:0xf
    v_and_b32_dpp v31, v9, v15 row_newbcast:1 row_mask:0xf bank_mask:0xf
    s_waitcnt vmcnt(17)
    v_mfma_f32_16x16x32_bf16 v[16:19], v[64:67], v[24:27], v[16:19]
    v_and_b32_dpp v24, v9, v12 row_newbcast:2 row_mask:0xf bank_mask:0xf
    v_and_b32_dpp v25, v9, v13 row_newbcast:2 row_mask:0xf bank_mask:0xf
    v_and_b32_dpp v26, v9, v14 row_newbcast:2 row_mask:0xf bank_mask:0xf
    v_and_b32_dpp v27, v9, v15 row_newbcast:2 row_mask:0xf bank_mask:0xf
    s_waitcnt vmcnt(16)
    v_mfma_f32_16x16x32_bf16 v[16:19], v[68:71], v[28:31], v[16:19]
    v_and_b32_dpp v28, v9, v12 row_newbcast:3 row_mask:0xf bank_mask:0xf
    v_and_b32_dpp v29, v9, v13 row_newbcast:3 row_mask:0xf bank_mask:0xf
    v_and_b32_dpp v30, v9, v14 row_newbcast:3 row_mask:0xf bank_mask:0xf
    v_and_b32_dpp v31, v9, v15 row_newbcast:3 row_mask:0xf bank_mask:0xf
    s_waitcnt vmcnt(15)
    v_mfma_f32_16x16x32_bf16 v[16:19], v[72:75], v[24:27], v[16:19]
    v_and_b32_dpp v24, v9, v12 row_newbcast:4 row_mask:0xf bank_mask:0xf
    v_and_b32_dpp v25, v9, v13 row_newbcast:4 row_mask:0xf bank_mask:0xf
    v_and_b32_dpp v26, v9, v14 row_newbcast:4 row_mask:0xf bank_mask:0xf
    v_and_b32_dpp v27, v9, v15 row_newbcast:4 row_mask:0xf bank_mask:0xf
    s_waitcnt vmcnt(14)
    v_mfma_f32_16x16x32_bf16 v[16:19], v[76:79], v[28:31], v[16:19]
    v_and_b32_dpp v28, v9, v12 row_newbcast:5 row_mask:0xf bank_mask:0xf
    v_and_b32_dpp v29, v9, v13 row_newbcast:5 row_mask:0xf bank_mask:0xf
    v_and_b32_dpp v30, v9, v14 row_newbcast:5 row_mask:0xf bank_mask:0xf
    v_and_b32_dpp v31, v9, v15 row_newbcast:5 row_mask:0xf bank_mask:0xf
    s_waitcnt vmcnt(13)
    v_mfma_f32_16x16x32_bf16 v[16:19], v[80:83], v[24:27], v[16:19]
    v_and_b32_dpp v24, v9, v12 row_newbcast:6 row_mask:0xf bank_mask:0xf
    v_and_b32_dpp v25, v9, v13 row_newbcast:6 row_mask:0xf bank_mask:0xf
    v_and_b32_dpp v26, v9, v14 row_newbcast:6 row_mask:0xf bank_mask:0xf
    v_and_b32_dpp v27, v9, v15 row_newbcast:6 row_mask:0xf bank_mask:0xf
    s_waitcnt vmcnt(12)
    v_mfma_f32_16x16x32_bf16 v[16:19], v[84:87], v[28:31], v[16:19]
    v_and_b32_dpp v28, v9, v12 row_newbcast:7 row_mask:0xf bank_mask:0xf
    v_and_b32_dpp v29, v9, v13 row_newbcast:7 row_mask:0xf bank_mask:0xf
    v_and_b32_dpp v30, v9, v14 row_newbcast:7 row_mask:0xf bank_mask:0xf
    v_and_b32_dpp v31, v9, v15 row_newbcast:7 row_mask:0xf bank_mask:0xf
    s_waitcnt vmcnt(11)
    v_mfma_f32_16x16x32_bf16 v[16:19], v[88:91], v[24:27], v[16:19]
    v_and_b32_dpp v24, v9, v12 row_newbcast:8 row_mask:0xf bank_mask:0xf
    v_and_b32_dpp v25, v9, v13 row_newbcast:8 row_mask:0xf bank_mask:0xf
    v_and_b32_dpp v26, v9, v14 row_newbcast:8 row_mask:0xf bank_mask:0xf
    v_and_b32_dpp v27, v9, v15 row_newbcast:8 row_mask:0xf bank_mask:0xf
    s_waitcnt vmcnt(10)
    v_mfma_f32_16x16x32_bf16 v[16:19], v[92:95], v[28:31], v[16:19]
    v_and_b32_dpp v28, v9, v12 row_newbcast:9 row_mask:0xf bank_mask:0xf
    v_and_b32_dpp v29, v9, v13 row_newbcast:9 row_mask:0xf bank_mask:0xf
    v_and_b32_dpp v30, v9, v14 row_newbcast:9 row_mask:0xf bank_mask:0xf
    v_and_b32_dpp v31, v9, v15 row_newbcast:9 row_mask:0xf bank_mask:0xf
    s_waitcnt vmcnt(9)
    v_mfma_f32_16x16x32_bf16 v[16:19], v[96:99], v[24:27], v[16:19]
    v_and_b32_dpp v24, v9, v12 row_newbcast:10 row_mask:0xf bank_mask:0xf
    v_and_b32_dpp v25, v9, v13 row_newbcast:10 row_mask:0xf bank_mask:0xf
    v_and_b32_dpp v26, v9, v14 row_newbcast:10 row_mask:0xf bank_mask:0xf
    v_and_b32_dpp v27, v9, v15 row_newbcast:10 row_mask:0xf bank_mask:0xf
    s_waitcnt vmcnt(8)
    v_mfma_f32_16x16x32_bf16 v[16:19], v[100:103], v[28:31], v[16:19]
    v_and_b32_dpp v28, v9, v12 row_newbcast:11 row_mask:0xf bank_mask:0xf
    v_and_b32_dpp v29, v9, v13 row_newbcast:11 row_mask:0xf bank_mask:0xf
    v_and_b32_dpp v30, v9, v14 row_newbcast:11 row_mask:0xf bank_mask:0xf
    v_and_b32_dpp v31, v9, v15 row_newbcast:11 row_mask:0xf bank_mask:0xf
    s_waitcnt vmcnt(7)
    v_mfma_f32_16x16x32_bf16 v[16:19], v[104:107], v[24:27], v[16:19]
    v_and_b32_dpp v24, v9, v12 row_newbcast:12 row_mask:0xf bank_mask:0xf
    v_and_b32_dpp v25, v9, v13 row_newbcast:12 row_mask:0xf bank_mask:0xf
    v_and_b32_dpp v26, v9, v14 row_newbcast:12 row_mask:0xf bank_mask:0xf
    v_and_b32_dpp v27, v9, v15 row_newbcast:12 row_mask:0xf bank_mask:0xf
    s_waitcnt vmcnt(6)
    v_mfma_f32_16x16x32_bf16 v[16:19], v[108:111], v[28:31], v[16:19]
    v_and_b32_dpp v28, v9, v12 row_newbcast:13 row_mask:0xf bank_mask:0xf
    v_and_b32_dpp v29, v9, v13 row_newbcast:13 row_mask:0xf bank_mask:0xf
    v_and_b32_dpp v30, v9, v14 row_newbcast:13 row_mask:0xf bank_mask:0xf
    v_and_b32_dpp v31, v9, v15 row_newbcast:13 row_mask:0xf bank_mask:0xf
    s_waitcnt vmcnt(5)
    v_mfma_f32_16x16x32_bf16 v[16:19], v[112:115], v[24:27], v[16:19]
    v_and_b32_dpp v24, v9, v12 row_newbcast:14 row_mask:0xf bank_mask:0xf
    v_and_b32_dpp v25, v9, v13 row_newbcast:14 row_mask:0xf bank_mask:0xf
    v_and_b32_dpp v26, v9, v14 row_newbcast:14 row_mask:0xf bank_mask:0xf
    v_and_b32_dpp v27, v9, v15 row_newbcast:14 row_mask:0xf bank_mask:0xf
    s_waitcnt vmcnt(4)
    v_mfma_f32_16x16x32_bf16 v[16:19], v[116:119], v[28:31], v[16:19]
    v_and_b32_dpp v28, v9, v12 row_newbcast:15 row_mask:0xf bank_mask:0xf
    v_and_b32_dpp v29, v9, v13 row_newbcast:15 row_mask:0xf bank_mask:0xf
    v_and_b32_dpp v30, v9, v14 row_newbcast:15 row_mask:0xf bank_mask:0xf
    v_and_b32_dpp v31, v9, v15 row_newbcast:15 row_mask:0xf bank_mask:0xf
    s_waitcnt vmcnt(3)
    v_mfma_f32_16x16x32_bf16 v[16:19], v[120:123], v[24:27], v[16:19]
    v_and_b32_dpp v24, v10, v12 row_newbcast:0 row_mask:0xf bank_mask:0xf
    v_and_b32_dpp v25, v10, v13 row_newbcast:0 row_mask:0xf bank_mask:0xf
    v_and_b32_dpp v26, v10, v14 row_newbcast:0 row_mask:0xf bank_mask:0xf
    v_and_b32_dpp v27, v10, v15 row_newbcast:0 row_mask:0xf bank_mask:0xf
    s_waitcnt vmcnt(2)
    v_mfma_f32_16x16x32_bf16 v[16:19], v[124:127], v[28:31], v[16:19]
    v_and_b32_dpp v28, v10, v12 row_newbcast:1 row_mask:0xf bank_mask:0xf
    v_and_b32_dpp v29, v10, v13 row_newbcast:1 row_mask:0xf bank_mask:0xf
    v_and_b32_dpp v30, v10, v14 row_newbcast:1 row_mask:0xf bank_mask:0xf
    v_and_b32_dpp v31, v10, v15 row_newbcast:1 row_mask:0xf bank_mask:0xf
    s_waitcnt vmcnt(1)
    v_mfma_f32_16x16x32_bf16 v[16:19], v[128:131], v[24:27], v[16:19]
    s_nop 1
    s_waitcnt vmcnt(0)
    v_mfma_f32_16x16x32_bf16 v[16:19], v[132:135], v[28:31], v[16:19]
    s_nop 7
    s_mov_b32 s52, 0xff00ff00
    s_mov_b32 s53, 0xff00ff00
    v_cndmask_b32 v20, v16, v18, s[52:53]
    v_cndmask_b32 v22, v17, v19, s[52:53]
    s_waitcnt lgkmcnt(0)
    s_mul_i32 s6, s6, 0x9E3779B1
    s_add_u32 s6, s6, 0x7F4A7C15

    v_lshlrev_b32 v24, 4, v0
    s_lshl_b32 s30, s2, 10
    s_add_u32 s30, s30, 65536
    v_add_u32 v24, s30, v24
    v_mov_b32 v21, s6
    v_mov_b32 v23, s6
    buffer_store_dwordx4 v[20:23], v24, s[44:47], 0 offen sc1

    s_lshl_b32 s30, s4, 13
    s_add_u32 s30, s30, 65536
    v_lshlrev_b32 v4, 4, v0
    v_add_u32 v4, s30, v4
    v_add_u32 v5, 4096, v4

    s_waitcnt vmcnt(0)
    buffer_load_dwordx4 v[24:27], v4, s[44:47], 0 offen offset:0 sc1
    buffer_load_dwordx4 v[28:31], v4, s[44:47], 0 offen offset:1024 sc1
    buffer_load_dwordx4 v[32:35], v4, s[44:47], 0 offen offset:2048 sc1
    buffer_load_dwordx4 v[36:39], v4, s[44:47], 0 offen offset:3072 sc1
    buffer_load_dwordx4 v[40:43], v5, s[44:47], 0 offen offset:0 sc1
    buffer_load_dwordx4 v[44:47], v5, s[44:47], 0 offen offset:1024 sc1
    buffer_load_dwordx4 v[48:51], v5, s[44:47], 0 offen offset:2048 sc1
    buffer_load_dwordx4 v[52:55], v5, s[44:47], 0 offen offset:3072 sc1
    s_barrier

    s_mov_b32 s36, s16
    s_mov_b32 s37, s17
    s_mov_b32 s38, 4718592
    s_mov_b32 s39, 0x20000
    v_lshrrev_b32 v58, 3, v3
    v_lshl_add_u32 v58, v2, 1, v58
    s_lshl_b32 s30, s2, 4
    v_add_u32 v58, s30, v58
    s_movk_i32 s31, 1152
    v_mul_lo_u32 v58, v58, s31
    v_and_b32 v59, 7, v3
    v_lshl_add_u32 v58, v59, 4, v58
    v_add_u32 v59, 9216, v58

    buffer_load_dwordx4 v[64:67], v58, s[36:39], 0 offen offset:0 nt
    buffer_load_dwordx4 v[68:71], v58, s[36:39], 0 offen offset:128 nt
    buffer_load_dwordx4 v[72:75], v58, s[36:39], 0 offen offset:256 nt
    buffer_load_dwordx4 v[76:79], v58, s[36:39], 0 offen offset:384 nt
    buffer_load_dwordx4 v[80:83], v58, s[36:39], 0 offen offset:512 nt
    buffer_load_dwordx4 v[84:87], v58, s[36:39], 0 offen offset:640 nt
    buffer_load_dwordx4 v[88:91], v58, s[36:39], 0 offen offset:768 nt
    buffer_load_dwordx4 v[92:95], v58, s[36:39], 0 offen offset:896 nt
    buffer_load_dwordx4 v[96:99], v58, s[36:39], 0 offen offset:1024 nt
    buffer_load_dwordx4 v[100:103], v59, s[36:39], 0 offen offset:0 nt
    buffer_load_dwordx4 v[104:107], v59, s[36:39], 0 offen offset:128 nt
    buffer_load_dwordx4 v[108:111], v59, s[36:39], 0 offen offset:256 nt
    buffer_load_dwordx4 v[112:115], v59, s[36:39], 0 offen offset:384 nt
    buffer_load_dwordx4 v[116:119], v59, s[36:39], 0 offen offset:512 nt
    buffer_load_dwordx4 v[120:123], v59, s[36:39], 0 offen offset:640 nt
    buffer_load_dwordx4 v[124:127], v59, s[36:39], 0 offen offset:768 nt
    buffer_load_dwordx4 v[128:131], v59, s[36:39], 0 offen offset:896 nt
    buffer_load_dwordx4 v[132:135], v59, s[36:39], 0 offen offset:1024 nt
    s_mov_b32 s49, 0
    s_waitcnt vmcnt(18)
    s_branch L_q_chk
L_q_poll:
    buffer_load_dwordx4 v[24:27], v4, s[44:47], 0 offen offset:0 sc1
    buffer_load_dwordx4 v[28:31], v4, s[44:47], 0 offen offset:1024 sc1
    buffer_load_dwordx4 v[32:35], v4, s[44:47], 0 offen offset:2048 sc1
    buffer_load_dwordx4 v[36:39], v4, s[44:47], 0 offen offset:3072 sc1
    buffer_load_dwordx4 v[40:43], v5, s[44:47], 0 offen offset:0 sc1
    buffer_load_dwordx4 v[44:47], v5, s[44:47], 0 offen offset:1024 sc1
    buffer_load_dwordx4 v[48:51], v5, s[44:47], 0 offen offset:2048 sc1
    buffer_load_dwordx4 v[52:55], v5, s[44:47], 0 offen offset:3072 sc1
    s_waitcnt vmcnt(0)
L_q_chk:
    v_xor_b32 v6, s6, v25
    v_xor_b32 v60, s6, v27
    v_or_b32 v6, v6, v60
    v_xor_b32 v60, s6, v29
    v_xor_b32 v61, s6, v31
    v_or3_b32 v6, v6, v60, v61
    v_xor_b32 v60, s6, v33
    v_xor_b32 v61, s6, v35
    v_or3_b32 v6, v6, v60, v61
    v_xor_b32 v60, s6, v37
    v_xor_b32 v61, s6, v39
    v_or3_b32 v6, v6, v60, v61
    v_xor_b32 v60, s6, v41
    v_xor_b32 v61, s6, v43
    v_or3_b32 v6, v6, v60, v61
    v_xor_b32 v60, s6, v45
    v_xor_b32 v61, s6, v47
    v_or3_b32 v6, v6, v60, v61
    v_xor_b32 v60, s6, v49
    v_xor_b32 v61, s6, v51
    v_or3_b32 v6, v6, v60, v61
    v_xor_b32 v60, s6, v53
    v_xor_b32 v61, s6, v55
    v_or3_b32 v6, v6, v60, v61
    v_cmp_ne_u32 vcc, 0, v6
    s_cbranch_vccz L_q_ok
    s_add_u32 s49, s49, 1
    s_cmp_lt_u32 s49, 40000
    s_cbranch_scc1 L_q_poll
L_q_ok:
    v_add_f32 v24, v24, v28
    v_add_f32 v32, v32, v36
    v_add_f32 v40, v40, v44
    v_add_f32 v48, v48, v52
    v_add_f32 v24, v24, v32
    v_add_f32 v40, v40, v48
    v_add_f32 v24, v24, v40
    v_add_f32 v26, v26, v30
    v_add_f32 v34, v34, v38
    v_add_f32 v42, v42, v46
    v_add_f32 v50, v50, v54
    v_add_f32 v26, v26, v34
    v_add_f32 v42, v42, v50
    v_add_f32 v26, v26, v42
    v_cvt_pk_bf16_f32 v24, v24, v26
    v_and_b32 v25, 8, v3
    v_add_u32 v25, v25, v3
    v_lshl_add_u32 v25, v2, 5, v25
    v_lshlrev_b32 v25, 1, v25
    ds_write_b16 v25, v24 offset:0
    ds_write_b16_d16_hi v25, v24 offset:16
    s_waitcnt lgkmcnt(0)
    v_mov_b32 v25, 324
    v_mov_b32 v26, 1
    ds_write_b32 v25, v26
    v_mov_b32 v140, 0
    v_mov_b32 v141, 0
    v_mov_b32 v142, 0
    v_mov_b32 v143, 0
    v_mov_b32 v144, 0
    v_mov_b32 v145, 0
    v_mov_b32 v146, 0
    v_mov_b32 v147, 0
    v_mov_b32 v148, 0
    v_mov_b32 v149, 0
    v_mov_b32 v150, 0
    v_mov_b32 v151, 0
    v_mov_b32 v152, 0
    v_mov_b32 v153, 0
    v_mov_b32 v154, 0
    v_mov_b32 v155, 0
    v_mov_b32 v156, 0
    v_mov_b32 v157, 0
    v_mov_b32 v158, 0
    v_mov_b32 v159, 0
    v_mov_b32 v160, 0
    v_mov_b32 v161, 0
    v_mov_b32 v162, 0
    v_mov_b32 v163, 0
    v_mov_b32 v164, 0
    v_mov_b32 v165, 0
    v_mov_b32 v166, 0
    v_mov_b32 v167, 0
    v_mov_b32 v168, 0
    v_mov_b32 v169, 0
    v_mov_b32 v170, 0
    v_mov_b32 v171, 0
    v_mov_b32 v172, 0
    v_mov_b32 v173, 0
    v_mov_b32 v174, 0
    v_mov_b32 v175, 0
    v_mov_b32 v179, s6
    v_mov_b32 v183, s6
    v_mov_b32 v187, s6
    v_and_b32 v20, 1, v2
    v_lshlrev_b32 v20, 2, v20
    v_lshrrev_b32 v21, 3, v3
    v_lshlrev_b32 v21, 1, v21
    v_add_u32 v20, v20, v21
    v_lshrrev_b32 v21, 1, v2
    v_add_u32 v20, v20, v21
    v_lshlrev_b32 v20, 1, v20
    v_bfe_u32 v21, v3, 2, 1
    v_add_u32 v20, v20, v21
    v_lshlrev_b32 v20, 14, v20
    v_and_b32 v21, 3, v3
    v_lshl_add_u32 v20, v21, 4, v20
    s_lshl_b32 s30, s2, 6
    s_add_u32 s30, s30, 6291456
    v_add_u32 v20, s30, v20

    v_lshrrev_b32 v56, 3, v3
    v_lshl_add_u32 v56, v2, 1, v56
    v_lshl_add_u32 v56, v2, 4, v56
    v_lshlrev_b32 v56, 2, v56
    v_add_u32 v57, 32, v56
    s_mov_b32 s60, 0x3fb8aa3b

    v_mov_b32 v4, 320
    s_mov_b32 s49, 0
L_ha_kw:
    ds_read_b32 v5, v4
    s_waitcnt lgkmcnt(0)
    v_readfirstlane_b32 s30, v5
    s_add_u32 s49, s49, 1
    s_cmp_ge_u32 s30, 256
    s_cbranch_scc1 L_ha_kd
    s_sleep 16
    s_cmp_lt_u32 s49, 160000
    s_cbranch_scc1 L_ha_kw
L_ha_kd:

    v_lshrrev_b32 v4, 3, v0
    v_and_b32 v4, 3, v4
    s_movk_i32 s30, 12288
    v_mul_lo_u32 v5, v4, s30
    v_lshrrev_b32 v6, 5, v0
    v_lshl_add_u32 v5, v6, 8, v5
    v_and_b32 v7, 7, v0
    v_lshl_add_u32 v5, v7, 3, v5
    v_lshlrev_b32 v4, 7, v4
    v_lshl_add_u32 v4, v6, 2, v4
    v_lshlrev_b32 v7, 4, v7
    s_mul_i32 s30, s4, 8192
    s_add_u32 s30, s30, 1310720
    v_add_u32 v7, s30, v7
    v_mov_b32 v9, 0x7f000000
    s_mov_b32 s62, 0x07060302
    v_mov_b32 v25, s6
    v_mov_b32 v27, s6
    s_mov_b32 s49, 0
L_pub:
    ds_read_b32 v8, v4 offset:53248
    ds_read_b32 v28, v5 offset:11776
    ds_read_b32 v29, v5 offset:11840
    ds_read_b32 v30, v5 offset:11904
    ds_read_b32 v31, v5 offset:11968
    s_waitcnt lgkmcnt(0)
    v_cmp_gt_u32 vcc, 64, v8
    s_cbranch_vccz L_pub_done
    v_lshl_add_u32 v6, v8, 7, v7
    v_perm_b32 v24, v29, v28, s62
    v_perm_b32 v26, v31, v30, s62
    v_cndmask_b32 v6, v9, v6, vcc
    buffer_store_dwordx4 v[24:27], v6, s[44:47], 0 offen sc1 nt
    v_add_u32 v4, 8, v4
    v_add_u32 v5, 512, v5
    s_add_u32 s49, s49, 1
    s_waitcnt vmcnt(0)
    s_cmp_lt_u32 s49, 9
    s_cbranch_scc1 L_pub
L_pub_done:

    s_lshl_b32 s30, s2, 11
    s_add_u32 s30, s30, 655360
    v_lshlrev_b32 v10, 4, v0
    v_add_u32 v10, s30, v10
    v_mov_b32 v11, s30
    s_lshl_b32 s30, s4, 14
    s_add_u32 s30, s30, 655360
    v_lshlrev_b32 v4, 11, v2
    v_add_u32 v4, s30, v4
    v_add_u32 v5, 8192, v4
    s_lshl_b32 s31, s5, 7
    v_lshl_add_u32 v6, v3, 3, s31
    v_add_u32 v7, v5, v6
    v_add_u32 v6, v4, v6
    v_mov_b32 v8, 0
    v_lshlrev_b32 v9, 3, v0
    v_mov_b32 v41, s6
    v_mov_b32 v43, s6
    v_mov_b32 v45, s6
    v_mov_b32 v47, s6
    s_waitcnt vmcnt(0)

    s_barrier

    ds_read_b128 v[24:27], v8 offset:256
    ds_read_b128 v[28:31], v8 offset:272
    ds_read_b64 v[32:33], v9 offset:512
    ds_read_b64 v[34:35], v9 offset:1024
    ds_read_b64 v[36:37], v9 offset:1536
    ds_read_b64 v[38:39], v9 offset:2048
    s_waitcnt lgkmcnt(4)
    v_max_f32 v40, v24, v26
    v_max3_f32 v40, v40, v28, v30
    v_sub_f32 v24, v24, v40
    v_sub_f32 v26, v26, v40
    v_sub_f32 v28, v28, v40
    v_sub_f32 v30, v30, v40
    v_mul_f32 v24, s60, v24
    v_mul_f32 v26, s60, v26
    v_mul_f32 v28, s60, v28
    v_mul_f32 v30, s60, v30
    v_exp_f32 v24, v24
    v_exp_f32 v26, v26
    v_exp_f32 v28, v28
    v_exp_f32 v30, v30
    s_waitcnt lgkmcnt(0)
    v_mul_f32 v42, v24, v25
    v_mul_f32 v44, v24, v32
    v_mul_f32 v46, v24, v33
    v_fmac_f32 v42, v26, v27
    v_fmac_f32 v44, v26, v34
    v_fmac_f32 v46, v26, v35
    v_fmac_f32 v42, v28, v29
    v_fmac_f32 v44, v28, v36
    v_fmac_f32 v46, v28, v37
    v_fmac_f32 v42, v30, v31
    v_fmac_f32 v44, v30, v38
    v_fmac_f32 v46, v30, v39
    buffer_store_dwordx4 v[44:47], v10, s[44:47], 0 offen sc1
    s_mov_b64 exec, 1
    buffer_store_dwordx4 v[40:43], v11, s[44:47], 0 offen offset:1024 sc1
    s_mov_b64 exec, -1

    buffer_load_dwordx2 v[24:25], v6, s[44:47], 0 offen sc1
    buffer_load_dwordx2 v[26:27], v7, s[44:47], 0 offen sc1
    buffer_load_dwordx4 v[28:31], v4, s[44:47], 0 offen offset:1024 sc1
    buffer_load_dwordx4 v[32:35], v5, s[44:47], 0 offen offset:1024 sc1

    v_mov_b32 v60, 324
    v_mov_b32 v61, 2
    ds_write_b32 v60, v61
    s_mov_b32 s49, 0
    s_branch L_ag_chk
L_ag_poll:

    buffer_load_dwordx2 v[24:25], v6, s[44:47], 0 offen sc1
    buffer_load_dwordx2 v[26:27], v7, s[44:47], 0 offen sc1
    buffer_load_dwordx4 v[28:31], v4, s[44:47], 0 offen offset:1024 sc1
    buffer_load_dwordx4 v[32:35], v5, s[44:47], 0 offen offset:1024 sc1

L_ag_chk:
    s_waitcnt vmcnt(0)
    v_xor_b32 v8, s6, v25
    v_xor_b32 v60, s6, v27
    v_or_b32 v8, v8, v60
    v_xor_b32 v60, s6, v29
    v_xor_b32 v61, s6, v31
    v_or3_b32 v8, v8, v60, v61
    v_xor_b32 v60, s6, v33
    v_xor_b32 v61, s6, v35
    v_or3_b32 v8, v8, v60, v61
    v_cmp_ne_u32 vcc, 0, v8
    s_cbranch_vccz L_ag_ok
    s_add_u32 s49, s49, 1
    s_cmp_lt_u32 s49, 40000
    s_cbranch_scc1 L_ag_poll
L_ag_ok:
    v_max_f32 v36, v28, v32
    v_mov_b32 v37, v36
    s_nop 1
    v_permlane16_swap_b32 v36, v37
    v_max_f32 v36, v36, v37
    v_mov_b32 v37, v36
    s_nop 1
    v_permlane32_swap_b32 v36, v37
    v_max_f32 v36, v36, v37

    v_sub_f32 v28, v28, v36
    v_sub_f32 v32, v32, v36
    v_mul_f32 v28, s60, v28
    v_mul_f32 v32, s60, v32
    v_exp_f32 v28, v28
    v_exp_f32 v32, v32
    s_nop 0
    v_mul_f32 v38, v28, v30
    v_mul_f32 v39, v28, v24
    v_fmac_f32 v38, v32, v34
    v_fmac_f32 v39, v32, v26
    v_mov_b32 v36, v38
    v_mov_b32 v37, v39
    s_nop 0
    v_permlane16_swap_b32 v38, v36
    v_permlane16_swap_b32 v39, v37
    v_add_f32 v38, v38, v36
    v_add_f32 v39, v39, v37
    v_mov_b32 v36, v38
    v_mov_b32 v37, v39
    s_nop 0
    v_permlane32_swap_b32 v38, v36
    v_permlane32_swap_b32 v39, v37
    v_add_f32 v38, v38, v36
    v_add_f32 v39, v39, v37
    v_rcp_f32 v40, v38
    s_nop 0

    v_mul_f32 v41, v39, v40
    v_fma_f32 v37, -v41, v38, v39
    v_fma_f32 v41, v37, v40, v41
    v_cvt_pk_bf16_f32 v41, v41, v41

    ds_bpermute_b32 v44, v56, v41
    ds_bpermute_b32 v45, v57, v41
    s_waitcnt vmcnt(0) lgkmcnt(0)

    v_and_b32 v24, v44, v12
    v_and_b32 v25, v44, v13
    v_and_b32 v26, v44, v14
    v_and_b32 v27, v44, v15
    s_nop 1
    v_mfma_f32_16x16x32_bf16 v[140:143], v[64:67], v[24:27], v[140:143]
    v_mfma_f32_16x16x32_bf16 v[144:147], v[68:71], v[24:27], v[144:147]
    v_mfma_f32_16x16x32_bf16 v[148:151], v[72:75], v[24:27], v[148:151]
    v_mfma_f32_16x16x32_bf16 v[152:155], v[76:79], v[24:27], v[152:155]
    v_mfma_f32_16x16x32_bf16 v[156:159], v[80:83], v[24:27], v[156:159]
    v_mfma_f32_16x16x32_bf16 v[160:163], v[84:87], v[24:27], v[160:163]
    v_mfma_f32_16x16x32_bf16 v[164:167], v[88:91], v[24:27], v[164:167]
    v_mfma_f32_16x16x32_bf16 v[168:171], v[92:95], v[24:27], v[168:171]
    v_mfma_f32_16x16x32_bf16 v[172:175], v[96:99], v[24:27], v[172:175]
    v_and_b32 v24, v45, v12
    v_and_b32 v25, v45, v13
    v_and_b32 v26, v45, v14
    v_and_b32 v27, v45, v15
    s_nop 1
    v_mfma_f32_16x16x32_bf16 v[140:143], v[100:103], v[24:27], v[140:143]
    v_mfma_f32_16x16x32_bf16 v[144:147], v[104:107], v[24:27], v[144:147]
    v_mfma_f32_16x16x32_bf16 v[148:151], v[108:111], v[24:27], v[148:151]
    v_mfma_f32_16x16x32_bf16 v[152:155], v[112:115], v[24:27], v[152:155]
    v_mfma_f32_16x16x32_bf16 v[156:159], v[116:119], v[24:27], v[156:159]
    v_mfma_f32_16x16x32_bf16 v[160:163], v[120:123], v[24:27], v[160:163]
    v_mfma_f32_16x16x32_bf16 v[164:167], v[124:127], v[24:27], v[164:167]
    v_mfma_f32_16x16x32_bf16 v[168:171], v[128:131], v[24:27], v[168:171]
    v_mfma_f32_16x16x32_bf16 v[172:175], v[132:135], v[24:27], v[172:175]
    s_nop 5
    v_permlane32_swap_b32 v140, v141
    v_permlane32_swap_b32 v142, v143
    v_permlane32_swap_b32 v144, v145
    v_permlane32_swap_b32 v146, v147
    v_permlane32_swap_b32 v148, v149
    v_permlane32_swap_b32 v150, v151
    v_permlane32_swap_b32 v152, v153
    v_permlane32_swap_b32 v154, v155
    v_permlane32_swap_b32 v156, v157
    v_permlane32_swap_b32 v158, v159
    v_permlane32_swap_b32 v160, v161
    v_permlane32_swap_b32 v162, v163
    v_permlane32_swap_b32 v164, v165
    v_permlane32_swap_b32 v166, v167
    v_permlane32_swap_b32 v168, v169
    v_permlane32_swap_b32 v170, v171
    v_permlane32_swap_b32 v172, v173
    v_permlane32_swap_b32 v174, v175
    v_add_f32_dpp v176, v141, v140 row_ror:8 row_mask:0xf bank_mask:0x3
    v_add_f32_dpp v176, v142, v143 row_ror:8 row_mask:0xf bank_mask:0xc
    v_add_f32_dpp v177, v145, v144 row_ror:8 row_mask:0xf bank_mask:0x3
    v_add_f32_dpp v177, v146, v147 row_ror:8 row_mask:0xf bank_mask:0xc
    v_add_f32_dpp v178, v149, v148 row_ror:8 row_mask:0xf bank_mask:0x3
    v_add_f32_dpp v178, v150, v151 row_ror:8 row_mask:0xf bank_mask:0xc
    s_mov_b32 s31, 0
    buffer_store_dwordx4 v[176:179], v20, s[44:47], s31 offen sc1
    v_add_f32_dpp v180, v153, v152 row_ror:8 row_mask:0xf bank_mask:0x3
    v_add_f32_dpp v180, v154, v155 row_ror:8 row_mask:0xf bank_mask:0xc
    v_add_f32_dpp v181, v157, v156 row_ror:8 row_mask:0xf bank_mask:0x3
    v_add_f32_dpp v181, v158, v159 row_ror:8 row_mask:0xf bank_mask:0xc
    v_add_f32_dpp v182, v161, v160 row_ror:8 row_mask:0xf bank_mask:0x3
    v_add_f32_dpp v182, v162, v163 row_ror:8 row_mask:0xf bank_mask:0xc
    s_mov_b32 s31, 262144
    buffer_store_dwordx4 v[180:183], v20, s[44:47], s31 offen sc1
    v_add_f32_dpp v184, v165, v164 row_ror:8 row_mask:0xf bank_mask:0x3
    v_add_f32_dpp v184, v166, v167 row_ror:8 row_mask:0xf bank_mask:0xc
    v_add_f32_dpp v185, v169, v168 row_ror:8 row_mask:0xf bank_mask:0x3
    v_add_f32_dpp v185, v170, v171 row_ror:8 row_mask:0xf bank_mask:0xc
    v_add_f32_dpp v186, v173, v172 row_ror:8 row_mask:0xf bank_mask:0x3
    v_add_f32_dpp v186, v174, v175 row_ror:8 row_mask:0xf bank_mask:0xc
    s_mov_b32 s31, 524288
    buffer_store_dwordx4 v[184:187], v20, s[44:47], s31 offen sc1
    s_endpgm
L_helperB:
    s_barrier

    s_mul_i32 s50, s2, 43691
    s_lshr_b32 s50, s50, 18
    s_mul_i32 s30, s50, 6
    s_sub_u32 s51, s2, s30
    s_mul_i32 s48, s51, 96

    s_mov_b32 s32, s8
    s_mov_b32 s33, s9
    s_mov_b32 s34, 1152
    s_mov_b32 s35, 0x20000
    v_lshlrev_b32 v20, 3, v0
    v_lshlrev_b32 v21, 1, v0
    v_lshl_add_u32 v22, v3, 2, v2
    v_add_u32 v22, s48, v22
    v_lshlrev_b32 v22, 1, v22
    buffer_load_dwordx2 v[4:5], v20, s[32:35], 0 offen
    buffer_load_dwordx2 v[6:7], v20, s[32:35], 0 offen offset:512
    buffer_load_ushort v8, v21, s[32:35], 0 offen offset:1024
    buffer_load_ushort v9, v22, s[32:35], 0 offen
    buffer_load_ushort v10, v22, s[32:35], 0 offen offset:128

    s_mov_b32 s36, s20
    s_mov_b32 s37, s21
    s_mov_b32 s38, 5308416
    s_mov_b32 s39, 0x20000
    v_add_u32 v23, s48, v2
    s_movk_i32 s31, 9216
    v_mul_lo_u32 v23, v23, s31
    v_lshl_add_u32 v23, v3, 4, v23
    s_lshl_b32 s30, s50, 8
    v_add_u32 v23, s30, v23
    s_cmp_lt_u32 s2, 216
    s_cbranch_scc1 L_hasw1
    v_mov_b32 v23, 0x7f000000
L_hasw1:

    s_mov_b32 s31, 0
    buffer_load_dwordx4 v[52:55], v23, s[36:39], s31 offen nt
    s_mov_b32 s31, 36864
    buffer_load_dwordx4 v[56:59], v23, s[36:39], s31 offen nt
    s_mov_b32 s31, 73728
    buffer_load_dwordx4 v[60:63], v23, s[36:39], s31 offen nt
    s_mov_b32 s31, 110592
    buffer_load_dwordx4 v[64:67], v23, s[36:39], s31 offen nt
    s_mov_b32 s31, 147456
    buffer_load_dwordx4 v[68:71], v23, s[36:39], s31 offen nt
    s_mov_b32 s31, 184320
    buffer_load_dwordx4 v[72:75], v23, s[36:39], s31 offen nt
    s_mov_b32 s31, 221184
    buffer_load_dwordx4 v[76:79], v23, s[36:39], s31 offen nt
    s_mov_b32 s31, 258048
    buffer_load_dwordx4 v[80:83], v23, s[36:39], s31 offen nt
    s_mov_b32 s31, 294912
    buffer_load_dwordx4 v[84:87], v23, s[36:39], s31 offen nt
    s_mov_b32 s31, 331776
    buffer_load_dwordx4 v[88:91], v23, s[36:39], s31 offen nt
    s_mov_b32 s31, 368640
    buffer_load_dwordx4 v[92:95], v23, s[36:39], s31 offen nt
    s_mov_b32 s31, 405504
    buffer_load_dwordx4 v[96:99], v23, s[36:39], s31 offen nt
    s_mov_b32 s31, 442368
    buffer_load_dwordx4 v[100:103], v23, s[36:39], s31 offen nt
    s_mov_b32 s31, 479232
    buffer_load_dwordx4 v[104:107], v23, s[36:39], s31 offen nt
    s_mov_b32 s31, 516096
    buffer_load_dwordx4 v[108:111], v23, s[36:39], s31 offen nt
    s_mov_b32 s31, 552960
    buffer_load_dwordx4 v[112:115], v23, s[36:39], s31 offen nt
    s_mov_b32 s31, 589824
    buffer_load_dwordx4 v[116:119], v23, s[36:39], s31 offen nt
    s_mov_b32 s31, 626688
    buffer_load_dwordx4 v[120:123], v23, s[36:39], s31 offen nt
    s_mov_b32 s31, 663552
    buffer_load_dwordx4 v[124:127], v23, s[36:39], s31 offen nt
    s_mov_b32 s31, 700416
    buffer_load_dwordx4 v[128:131], v23, s[36:39], s31 offen nt
    s_mov_b32 s31, 737280
    buffer_load_dwordx4 v[132:135], v23, s[36:39], s31 offen nt
    s_mov_b32 s31, 774144
    buffer_load_dwordx4 v[136:139], v23, s[36:39], s31 offen nt
    s_mov_b32 s31, 811008
    buffer_load_dwordx4 v[140:143], v23, s[36:39], s31 offen nt
    s_mov_b32 s31, 847872
    buffer_load_dwordx4 v[144:147], v23, s[36:39], s31 offen nt
    s_barrier

    s_mul_i32 s86, s2, 9
    s_lshr_b32 s87, s86, 2
    s_add_u32 s86, s86, 9
    s_lshr_b32 s86, s86, 2
    s_sub_u32 s86, s86, s87
    s_mov_b32 s40, s22
    s_mov_b32 s41, s23
    s_mov_b32 s42, 5308416
    s_mov_b32 s43, 0x20000
    v_lshrrev_b32 v40, 3, v3
    v_lshl_add_u32 v40, v2, 1, v40
    s_lshl_b32 s30, s87, 3
    v_add_u32 v40, s30, v40
    s_movk_i32 s31, 1152
    v_mul_lo_u32 v40, v40, s31
    v_and_b32 v41, 7, v3
    v_lshl_add_u32 v40, v41, 4, v40
    v_add_u32 v41, 9216, v40
    v_add_u32 v42, 18432, v40
    s_cmp_eq_u32 s86, 3
    s_cbranch_scc1 L_cnt3
    v_mov_b32 v42, 0x7f000000
L_cnt3:

    buffer_load_dwordx4 v[148:151], v40, s[40:43], 0 offen offset:0 nt
    buffer_load_dwordx4 v[152:155], v40, s[40:43], 0 offen offset:128 nt
    buffer_load_dwordx4 v[156:159], v40, s[40:43], 0 offen offset:256 nt
    buffer_load_dwordx4 v[160:163], v40, s[40:43], 0 offen offset:384 nt
    buffer_load_dwordx4 v[164:167], v40, s[40:43], 0 offen offset:512 nt
    buffer_load_dwordx4 v[168:171], v40, s[40:43], 0 offen offset:640 nt
    buffer_load_dwordx4 v[172:175], v40, s[40:43], 0 offen offset:768 nt
    buffer_load_dwordx4 v[176:179], v40, s[40:43], 0 offen offset:896 nt
    buffer_load_dwordx4 v[180:183], v40, s[40:43], 0 offen offset:1024 nt
    buffer_load_dwordx4 v[184:187], v41, s[40:43], 0 offen offset:0 nt
    buffer_load_dwordx4 v[188:191], v41, s[40:43], 0 offen offset:128 nt
    buffer_load_dwordx4 v[192:195], v41, s[40:43], 0 offen offset:256 nt
    buffer_load_dwordx4 v[196:199], v41, s[40:43], 0 offen offset:384 nt
    buffer_load_dwordx4 v[200:203], v41, s[40:43], 0 offen offset:512 nt
    buffer_load_dwordx4 v[204:207], v41, s[40:43], 0 offen offset:640 nt
    buffer_load_dwordx4 v[208:211], v41, s[40:43], 0 offen offset:768 nt
    buffer_load_dwordx4 v[212:215], v41, s[40:43], 0 offen offset:896 nt
    buffer_load_dwordx4 v[216:219], v41, s[40:43], 0 offen offset:1024 nt
    buffer_load_dwordx4 v[220:223], v42, s[40:43], 0 offen offset:0 nt
    buffer_load_dwordx4 v[224:227], v42, s[40:43], 0 offen offset:128 nt
    buffer_load_dwordx4 v[228:231], v42, s[40:43], 0 offen offset:256 nt
    buffer_load_dwordx4 v[232:235], v42, s[40:43], 0 offen offset:384 nt
    buffer_load_dwordx4 v[236:239], v42, s[40:43], 0 offen offset:512 nt
    buffer_load_dwordx4 v[240:243], v42, s[40:43], 0 offen offset:640 nt
    buffer_load_dwordx4 v[244:247], v42, s[40:43], 0 offen offset:768 nt
    buffer_load_dwordx4 v[248:251], v42, s[40:43], 0 offen offset:896 nt
    buffer_load_dwordx4 v[252:255], v42, s[40:43], 0 offen offset:1024 nt
    v_and_b32 v20, 7, v3
    v_and_b32 v21, 1, v3
    v_lshlrev_b32 v21, 4, v21
    v_mov_b32 v12, 0xffff
    v_lshlrev_b32 v21, v21, v12
    v_lshrrev_b32 v20, 1, v20
    v_cmp_eq_u32 vcc, 0, v20
    s_nop 1
    v_cndmask_b32 v12, 0, v21, vcc
    v_cmp_eq_u32 vcc, 1, v20
    s_nop 1
    v_cndmask_b32 v13, 0, v21, vcc
    v_cmp_eq_u32 vcc, 2, v20
    s_nop 1
    v_cndmask_b32 v14, 0, v21, vcc
    v_cmp_eq_u32 vcc, 3, v20
    s_nop 1
    v_cndmask_b32 v15, 0, v21, vcc
    s_waitcnt vmcnt(51)
    v_lshlrev_b32 v24, 16, v4
    v_and_b32 v25, 0xffff0000, v4
    v_lshlrev_b32 v26, 16, v5
    v_and_b32 v27, 0xffff0000, v5
    v_lshlrev_b32 v28, 16, v6
    v_and_b32 v29, 0xffff0000, v6
    v_lshlrev_b32 v30, 16, v7
    v_and_b32 v31, 0xffff0000, v7
    v_lshlrev_b32 v32, 16, v8
    v_add_f32 v33, v24, v25
    v_add_f32 v34, v26, v27
    v_add_f32 v35, v28, v29
    v_add_f32 v36, v30, v31
    v_add_f32 v33, v33, v34
    v_add_f32 v35, v35, v36
    v_add_f32 v33, v33, v32
    v_add_f32 v33, v33, v35
    s_nop 1
    v_add_f32_dpp v33, v33, v33 row_ror:8 row_mask:0xf bank_mask:0xf
    s_nop 1
    v_add_f32_dpp v33, v33, v33 row_ror:4 row_mask:0xf bank_mask:0xf
    s_nop 1
    v_add_f32_dpp v33, v33, v33 row_ror:2 row_mask:0xf bank_mask:0xf
    s_nop 1
    v_add_f32_dpp v33, v33, v33 row_ror:1 row_mask:0xf bank_mask:0xf
    v_mov_b32 v34, v33
    s_nop 1
    v_permlane16_swap_b32 v33, v34
    v_add_f32 v33, v33, v34
    v_mov_b32 v34, v33
    s_nop 1
    v_permlane32_swap_b32 v33, v34
    v_add_f32 v33, v33, v34
    v_mov_b32 v36, 0x44100000
    v_mov_b32 v37, 0x3ae38e39
    v_mul_f32 v38, v33, v37
    v_fma_f32 v34, -v38, v36, v33
    v_fma_f32 v38, v34, v37, v38
    v_sub_f32 v24, v24, v38
    v_sub_f32 v25, v25, v38
    v_sub_f32 v26, v26, v38
    v_sub_f32 v27, v27, v38
    v_sub_f32 v28, v28, v38
    v_sub_f32 v29, v29, v38
    v_sub_f32 v30, v30, v38
    v_sub_f32 v31, v31, v38
    v_sub_f32 v32, v32, v38
    v_mul_f32 v33, v24, v24
    v_fmac_f32 v33, v25, v25
    v_fmac_f32 v33, v26, v26
    v_fmac_f32 v33, v27, v27
    v_fmac_f32 v33, v28, v28
    v_fmac_f32 v33, v29, v29
    v_fmac_f32 v33, v30, v30
    v_fmac_f32 v33, v31, v31
    v_fmac_f32 v33, v32, v32
    s_nop 1
    v_add_f32_dpp v33, v33, v33 row_ror:8 row_mask:0xf bank_mask:0xf
    s_nop 1
    v_add_f32_dpp v33, v33, v33 row_ror:4 row_mask:0xf bank_mask:0xf
    s_nop 1
    v_add_f32_dpp v33, v33, v33 row_ror:2 row_mask:0xf bank_mask:0xf
    s_nop 1
    v_add_f32_dpp v33, v33, v33 row_ror:1 row_mask:0xf bank_mask:0xf
    v_mov_b32 v34, v33
    s_nop 1
    v_permlane16_swap_b32 v33, v34
    v_add_f32 v33, v33, v34
    v_mov_b32 v34, v33
    s_nop 1
    v_permlane32_swap_b32 v33, v34
    v_add_f32 v33, v33, v34
    v_mul_f32 v39, v33, v37
    v_fma_f32 v34, -v39, v36, v33
    v_fma_f32 v39, v34, v37, v39
    v_cvt_pk_bf16_f32 v38, v38, v38
    v_and_b32 v38, 0xffff0000, v38
    v_cvt_pk_bf16_f32 v39, v39, v39
    v_and_b32 v39, 0xffff0000, v39
    v_add_f32 v39, 0x3727c5ac, v39
    v_cvt_pk_bf16_f32 v39, v39, v39
    v_and_b32 v39, 0xffff0000, v39
    v_sqrt_f32 v39, v39
    s_nop 0
    v_cvt_pk_bf16_f32 v39, v39, v39
    v_and_b32 v39, 0xffff0000, v39
    v_rcp_f32 v37, v39
    v_lshlrev_b32 v9, 16, v9
    v_sub_f32 v9, v9, v38
    v_cvt_pk_bf16_f32 v9, v9, v9
    v_and_b32 v9, 0xffff0000, v9
    v_lshlrev_b32 v10, 16, v10
    v_sub_f32 v10, v10, v38
    v_cvt_pk_bf16_f32 v10, v10, v10
    v_and_b32 v10, 0xffff0000, v10
    v_mul_f32 v33, v9, v37
    v_fma_f32 v34, -v33, v39, v9
    v_fma_f32 v33, v34, v37, v33
    v_cvt_pk_bf16_f32 v9, v33, v33
    v_mul_f32 v33, v10, v37
    v_fma_f32 v34, -v33, v39, v10
    v_fma_f32 v33, v34, v37, v33
    v_cvt_pk_bf16_f32 v10, v33, v33
    v_mov_b32 v16, 0
    v_mov_b32 v17, 0
    v_mov_b32 v18, 0
    v_mov_b32 v19, 0
    s_nop 1
    v_and_b32_dpp v24, v9, v12 row_newbcast:0 row_mask:0xf bank_mask:0xf
    v_and_b32_dpp v25, v9, v13 row_newbcast:0 row_mask:0xf bank_mask:0xf
    v_and_b32_dpp v26, v9, v14 row_newbcast:0 row_mask:0xf bank_mask:0xf
    v_and_b32_dpp v27, v9, v15 row_newbcast:0 row_mask:0xf bank_mask:0xf
    v_and_b32_dpp v28, v9, v12 row_newbcast:1 row_mask:0xf bank_mask:0xf
    v_and_b32_dpp v29, v9, v13 row_newbcast:1 row_mask:0xf bank_mask:0xf
    v_and_b32_dpp v30, v9, v14 row_newbcast:1 row_mask:0xf bank_mask:0xf
    v_and_b32_dpp v31, v9, v15 row_newbcast:1 row_mask:0xf bank_mask:0xf
    s_waitcnt vmcnt(50)
    v_mfma_f32_16x16x32_bf16 v[16:19], v[52:55], v[24:27], v[16:19]
    v_and_b32_dpp v24, v9, v12 row_newbcast:2 row_mask:0xf bank_mask:0xf
    v_and_b32_dpp v25, v9, v13 row_newbcast:2 row_mask:0xf bank_mask:0xf
    v_and_b32_dpp v26, v9, v14 row_newbcast:2 row_mask:0xf bank_mask:0xf
    v_and_b32_dpp v27, v9, v15 row_newbcast:2 row_mask:0xf bank_mask:0xf
    s_waitcnt vmcnt(49)
    v_mfma_f32_16x16x32_bf16 v[16:19], v[56:59], v[28:31], v[16:19]
    v_and_b32_dpp v28, v9, v12 row_newbcast:3 row_mask:0xf bank_mask:0xf
    v_and_b32_dpp v29, v9, v13 row_newbcast:3 row_mask:0xf bank_mask:0xf
    v_and_b32_dpp v30, v9, v14 row_newbcast:3 row_mask:0xf bank_mask:0xf
    v_and_b32_dpp v31, v9, v15 row_newbcast:3 row_mask:0xf bank_mask:0xf
    s_waitcnt vmcnt(48)
    v_mfma_f32_16x16x32_bf16 v[16:19], v[60:63], v[24:27], v[16:19]
    v_and_b32_dpp v24, v9, v12 row_newbcast:4 row_mask:0xf bank_mask:0xf
    v_and_b32_dpp v25, v9, v13 row_newbcast:4 row_mask:0xf bank_mask:0xf
    v_and_b32_dpp v26, v9, v14 row_newbcast:4 row_mask:0xf bank_mask:0xf
    v_and_b32_dpp v27, v9, v15 row_newbcast:4 row_mask:0xf bank_mask:0xf
    s_waitcnt vmcnt(47)
    v_mfma_f32_16x16x32_bf16 v[16:19], v[64:67], v[28:31], v[16:19]
    v_and_b32_dpp v28, v9, v12 row_newbcast:5 row_mask:0xf bank_mask:0xf
    v_and_b32_dpp v29, v9, v13 row_newbcast:5 row_mask:0xf bank_mask:0xf
    v_and_b32_dpp v30, v9, v14 row_newbcast:5 row_mask:0xf bank_mask:0xf
    v_and_b32_dpp v31, v9, v15 row_newbcast:5 row_mask:0xf bank_mask:0xf
    s_waitcnt vmcnt(46)
    v_mfma_f32_16x16x32_bf16 v[16:19], v[68:71], v[24:27], v[16:19]
    v_and_b32_dpp v24, v9, v12 row_newbcast:6 row_mask:0xf bank_mask:0xf
    v_and_b32_dpp v25, v9, v13 row_newbcast:6 row_mask:0xf bank_mask:0xf
    v_and_b32_dpp v26, v9, v14 row_newbcast:6 row_mask:0xf bank_mask:0xf
    v_and_b32_dpp v27, v9, v15 row_newbcast:6 row_mask:0xf bank_mask:0xf
    s_waitcnt vmcnt(45)
    v_mfma_f32_16x16x32_bf16 v[16:19], v[72:75], v[28:31], v[16:19]
    v_and_b32_dpp v28, v9, v12 row_newbcast:7 row_mask:0xf bank_mask:0xf
    v_and_b32_dpp v29, v9, v13 row_newbcast:7 row_mask:0xf bank_mask:0xf
    v_and_b32_dpp v30, v9, v14 row_newbcast:7 row_mask:0xf bank_mask:0xf
    v_and_b32_dpp v31, v9, v15 row_newbcast:7 row_mask:0xf bank_mask:0xf
    s_waitcnt vmcnt(44)
    v_mfma_f32_16x16x32_bf16 v[16:19], v[76:79], v[24:27], v[16:19]
    v_and_b32_dpp v24, v9, v12 row_newbcast:8 row_mask:0xf bank_mask:0xf
    v_and_b32_dpp v25, v9, v13 row_newbcast:8 row_mask:0xf bank_mask:0xf
    v_and_b32_dpp v26, v9, v14 row_newbcast:8 row_mask:0xf bank_mask:0xf
    v_and_b32_dpp v27, v9, v15 row_newbcast:8 row_mask:0xf bank_mask:0xf
    s_waitcnt vmcnt(43)
    v_mfma_f32_16x16x32_bf16 v[16:19], v[80:83], v[28:31], v[16:19]
    v_and_b32_dpp v28, v9, v12 row_newbcast:9 row_mask:0xf bank_mask:0xf
    v_and_b32_dpp v29, v9, v13 row_newbcast:9 row_mask:0xf bank_mask:0xf
    v_and_b32_dpp v30, v9, v14 row_newbcast:9 row_mask:0xf bank_mask:0xf
    v_and_b32_dpp v31, v9, v15 row_newbcast:9 row_mask:0xf bank_mask:0xf
    s_waitcnt vmcnt(42)
    v_mfma_f32_16x16x32_bf16 v[16:19], v[84:87], v[24:27], v[16:19]
    v_and_b32_dpp v24, v9, v12 row_newbcast:10 row_mask:0xf bank_mask:0xf
    v_and_b32_dpp v25, v9, v13 row_newbcast:10 row_mask:0xf bank_mask:0xf
    v_and_b32_dpp v26, v9, v14 row_newbcast:10 row_mask:0xf bank_mask:0xf
    v_and_b32_dpp v27, v9, v15 row_newbcast:10 row_mask:0xf bank_mask:0xf
    s_waitcnt vmcnt(41)
    v_mfma_f32_16x16x32_bf16 v[16:19], v[88:91], v[28:31], v[16:19]
    v_and_b32_dpp v28, v9, v12 row_newbcast:11 row_mask:0xf bank_mask:0xf
    v_and_b32_dpp v29, v9, v13 row_newbcast:11 row_mask:0xf bank_mask:0xf
    v_and_b32_dpp v30, v9, v14 row_newbcast:11 row_mask:0xf bank_mask:0xf
    v_and_b32_dpp v31, v9, v15 row_newbcast:11 row_mask:0xf bank_mask:0xf
    s_waitcnt vmcnt(40)
    v_mfma_f32_16x16x32_bf16 v[16:19], v[92:95], v[24:27], v[16:19]
    v_and_b32_dpp v24, v9, v12 row_newbcast:12 row_mask:0xf bank_mask:0xf
    v_and_b32_dpp v25, v9, v13 row_newbcast:12 row_mask:0xf bank_mask:0xf
    v_and_b32_dpp v26, v9, v14 row_newbcast:12 row_mask:0xf bank_mask:0xf
    v_and_b32_dpp v27, v9, v15 row_newbcast:12 row_mask:0xf bank_mask:0xf
    s_waitcnt vmcnt(39)
    v_mfma_f32_16x16x32_bf16 v[16:19], v[96:99], v[28:31], v[16:19]
    v_and_b32_dpp v28, v9, v12 row_newbcast:13 row_mask:0xf bank_mask:0xf
    v_and_b32_dpp v29, v9, v13 row_newbcast:13 row_mask:0xf bank_mask:0xf
    v_and_b32_dpp v30, v9, v14 row_newbcast:13 row_mask:0xf bank_mask:0xf
    v_and_b32_dpp v31, v9, v15 row_newbcast:13 row_mask:0xf bank_mask:0xf
    s_waitcnt vmcnt(38)
    v_mfma_f32_16x16x32_bf16 v[16:19], v[100:103], v[24:27], v[16:19]
    v_and_b32_dpp v24, v9, v12 row_newbcast:14 row_mask:0xf bank_mask:0xf
    v_and_b32_dpp v25, v9, v13 row_newbcast:14 row_mask:0xf bank_mask:0xf
    v_and_b32_dpp v26, v9, v14 row_newbcast:14 row_mask:0xf bank_mask:0xf
    v_and_b32_dpp v27, v9, v15 row_newbcast:14 row_mask:0xf bank_mask:0xf
    s_waitcnt vmcnt(37)
    v_mfma_f32_16x16x32_bf16 v[16:19], v[104:107], v[28:31], v[16:19]
    v_and_b32_dpp v28, v9, v12 row_newbcast:15 row_mask:0xf bank_mask:0xf
    v_and_b32_dpp v29, v9, v13 row_newbcast:15 row_mask:0xf bank_mask:0xf
    v_and_b32_dpp v30, v9, v14 row_newbcast:15 row_mask:0xf bank_mask:0xf
    v_and_b32_dpp v31, v9, v15 row_newbcast:15 row_mask:0xf bank_mask:0xf
    s_waitcnt vmcnt(36)
    v_mfma_f32_16x16x32_bf16 v[16:19], v[108:111], v[24:27], v[16:19]
    v_and_b32_dpp v24, v10, v12 row_newbcast:0 row_mask:0xf bank_mask:0xf
    v_and_b32_dpp v25, v10, v13 row_newbcast:0 row_mask:0xf bank_mask:0xf
    v_and_b32_dpp v26, v10, v14 row_newbcast:0 row_mask:0xf bank_mask:0xf
    v_and_b32_dpp v27, v10, v15 row_newbcast:0 row_mask:0xf bank_mask:0xf
    s_waitcnt vmcnt(35)
    v_mfma_f32_16x16x32_bf16 v[16:19], v[112:115], v[28:31], v[16:19]
    v_and_b32_dpp v28, v10, v12 row_newbcast:1 row_mask:0xf bank_mask:0xf
    v_and_b32_dpp v29, v10, v13 row_newbcast:1 row_mask:0xf bank_mask:0xf
    v_and_b32_dpp v30, v10, v14 row_newbcast:1 row_mask:0xf bank_mask:0xf
    v_and_b32_dpp v31, v10, v15 row_newbcast:1 row_mask:0xf bank_mask:0xf
    s_waitcnt vmcnt(34)
    v_mfma_f32_16x16x32_bf16 v[16:19], v[116:119], v[24:27], v[16:19]
    v_and_b32_dpp v24, v10, v12 row_newbcast:2 row_mask:0xf bank_mask:0xf
    v_and_b32_dpp v25, v10, v13 row_newbcast:2 row_mask:0xf bank_mask:0xf
    v_and_b32_dpp v26, v10, v14 row_newbcast:2 row_mask:0xf bank_mask:0xf
    v_and_b32_dpp v27, v10, v15 row_newbcast:2 row_mask:0xf bank_mask:0xf
    s_waitcnt vmcnt(33)
    v_mfma_f32_16x16x32_bf16 v[16:19], v[120:123], v[28:31], v[16:19]
    v_and_b32_dpp v28, v10, v12 row_newbcast:3 row_mask:0xf bank_mask:0xf
    v_and_b32_dpp v29, v10, v13 row_newbcast:3 row_mask:0xf bank_mask:0xf
    v_and_b32_dpp v30, v10, v14 row_newbcast:3 row_mask:0xf bank_mask:0xf
    v_and_b32_dpp v31, v10, v15 row_newbcast:3 row_mask:0xf bank_mask:0xf
    s_waitcnt vmcnt(32)
    v_mfma_f32_16x16x32_bf16 v[16:19], v[124:127], v[24:27], v[16:19]
    v_and_b32_dpp v24, v10, v12 row_newbcast:4 row_mask:0xf bank_mask:0xf
    v_and_b32_dpp v25, v10, v13 row_newbcast:4 row_mask:0xf bank_mask:0xf
    v_and_b32_dpp v26, v10, v14 row_newbcast:4 row_mask:0xf bank_mask:0xf
    v_and_b32_dpp v27, v10, v15 row_newbcast:4 row_mask:0xf bank_mask:0xf
    s_waitcnt vmcnt(31)
    v_mfma_f32_16x16x32_bf16 v[16:19], v[128:131], v[28:31], v[16:19]
    v_and_b32_dpp v28, v10, v12 row_newbcast:5 row_mask:0xf bank_mask:0xf
    v_and_b32_dpp v29, v10, v13 row_newbcast:5 row_mask:0xf bank_mask:0xf
    v_and_b32_dpp v30, v10, v14 row_newbcast:5 row_mask:0xf bank_mask:0xf
    v_and_b32_dpp v31, v10, v15 row_newbcast:5 row_mask:0xf bank_mask:0xf
    s_waitcnt vmcnt(30)
    v_mfma_f32_16x16x32_bf16 v[16:19], v[132:135], v[24:27], v[16:19]
    v_and_b32_dpp v24, v10, v12 row_newbcast:6 row_mask:0xf bank_mask:0xf
    v_and_b32_dpp v25, v10, v13 row_newbcast:6 row_mask:0xf bank_mask:0xf
    v_and_b32_dpp v26, v10, v14 row_newbcast:6 row_mask:0xf bank_mask:0xf
    v_and_b32_dpp v27, v10, v15 row_newbcast:6 row_mask:0xf bank_mask:0xf
    s_waitcnt vmcnt(29)
    v_mfma_f32_16x16x32_bf16 v[16:19], v[136:139], v[28:31], v[16:19]
    v_and_b32_dpp v28, v10, v12 row_newbcast:7 row_mask:0xf bank_mask:0xf
    v_and_b32_dpp v29, v10, v13 row_newbcast:7 row_mask:0xf bank_mask:0xf
    v_and_b32_dpp v30, v10, v14 row_newbcast:7 row_mask:0xf bank_mask:0xf
    v_and_b32_dpp v31, v10, v15 row_newbcast:7 row_mask:0xf bank_mask:0xf
    s_waitcnt vmcnt(28)
    v_mfma_f32_16x16x32_bf16 v[16:19], v[140:143], v[24:27], v[16:19]
    s_nop 1
    s_waitcnt vmcnt(27)
    v_mfma_f32_16x16x32_bf16 v[16:19], v[144:147], v[28:31], v[16:19]
    s_nop 7
    s_mov_b32 s52, 0xff00ff00
    s_mov_b32 s53, 0xff00ff00
    v_cndmask_b32 v20, v16, v18, s[52:53]
    v_cndmask_b32 v22, v17, v19, s[52:53]
    s_waitcnt lgkmcnt(0)
    s_mul_i32 s6, s6, 0x9E3779B1
    s_add_u32 s6, s6, 0x7F4A7C15

    v_lshlrev_b32 v24, 4, v0
    s_mul_i32 s30, s51, 36864
    s_lshl_b32 s31, s50, 10
    s_add_u32 s30, s30, s31
    s_add_u32 s30, s30, 393216
    v_add_u32 v24, s30, v24
    v_mov_b32 v21, s6
    v_mov_b32 v23, s6
    s_cmp_lt_u32 s2, 216
    s_cbranch_scc0 L_nopubh
    buffer_store_dwordx4 v[20:23], v24, s[44:47], 0 offen sc1
L_nopubh:

    v_lshrrev_b32 v4, 5, v0
    s_mov_b32 s31, 36864
    v_mul_lo_u32 v4, v4, s31
    v_and_b32 v5, 31, v0
    s_lshl_b32 s30, s86, 3
    v_cmp_gt_u32 s[54:55], s30, v5
    s_lshl_b32 s30, s87, 3
    v_add_u32 v5, s30, v5
    v_lshrrev_b32 v6, 4, v5
    v_lshlrev_b32 v6, 3, v6
    v_and_b32 v7, 7, v5
    v_add_u32 v6, v6, v7
    v_lshlrev_b32 v6, 4, v6
    v_bfe_u32 v7, v5, 3, 1
    v_lshl_add_u32 v6, v7, 3, v6
    v_add_u32 v4, v4, v6
    v_add_u32 v4, 393216, v4
    v_add_u32 v5, 73728, v4
    v_add_u32 v6, 147456, v4

    v_mov_b32 v52, 0
    v_mov_b32 v53, 0
    v_mov_b32 v54, 0
    v_mov_b32 v55, 0
    v_mov_b32 v56, 0
    v_mov_b32 v57, 0
    v_mov_b32 v58, 0
    v_mov_b32 v59, 0
    v_mov_b32 v60, 0
    v_mov_b32 v61, 0
    v_mov_b32 v62, 0
    v_mov_b32 v63, 0
    v_mov_b32 v64, 0
    v_mov_b32 v65, 0
    v_mov_b32 v66, 0
    v_mov_b32 v67, 0
    v_mov_b32 v68, 0
    v_mov_b32 v69, 0
    v_mov_b32 v70, 0
    v_mov_b32 v71, 0
    v_mov_b32 v72, 0
    v_mov_b32 v73, 0
    v_mov_b32 v74, 0
    v_mov_b32 v75, 0
    v_mov_b32 v76, 0
    v_mov_b32 v77, 0
    v_mov_b32 v78, 0
    v_mov_b32 v79, 0
    v_mov_b32 v80, 0
    v_mov_b32 v81, 0
    v_mov_b32 v82, 0
    v_mov_b32 v83, 0
    v_mov_b32 v84, 0
    v_mov_b32 v85, 0
    v_mov_b32 v86, 0
    v_mov_b32 v87, 0
    v_mov_b32 v91, s6
    v_mov_b32 v95, s6
    v_mov_b32 v99, s6
    v_and_b32 v20, 1, v2
    v_lshlrev_b32 v20, 2, v20
    v_lshrrev_b32 v21, 3, v3
    v_lshlrev_b32 v21, 1, v21
    v_add_u32 v20, v20, v21
    v_lshrrev_b32 v21, 1, v2
    v_add_u32 v20, v20, v21
    v_lshlrev_b32 v20, 1, v20
    v_bfe_u32 v21, v3, 2, 1
    v_add_u32 v20, v20, v21
    v_lshlrev_b32 v20, 14, v20
    v_and_b32 v21, 3, v3
    v_lshl_add_u32 v20, v21, 4, v20
    s_lshl_b32 s30, s2, 6
    s_add_u32 s30, s30, 7602176
    v_add_u32 v20, s30, v20
    v_mov_b32 v40, 320
    s_mov_b32 s49, 0
L_hb_kw:
    ds_read_b32 v41, v40
    s_waitcnt lgkmcnt(0)
    v_readfirstlane_b32 s30, v41
    s_add_u32 s49, s49, 1
    s_cmp_ge_u32 s30, 256
    s_cbranch_scc1 L_hb_kd
    s_sleep 16
    s_cmp_lt_u32 s49, 160000
    s_cbranch_scc1 L_hb_kw
L_hb_kd:
    s_mov_b32 s49, 0
L_h_poll:

    buffer_load_dwordx2 v[28:29], v4, s[44:47], 0 offen sc1
    buffer_load_dwordx2 v[30:31], v5, s[44:47], 0 offen sc1
    buffer_load_dwordx2 v[32:33], v6, s[44:47], 0 offen sc1
    s_waitcnt vmcnt(0)

    v_xor_b32 v8, s6, v29
    v_xor_b32 v46, s6, v31
    v_or_b32 v8, v8, v46
    v_xor_b32 v46, s6, v33
    v_or_b32 v8, v8, v46
    v_cndmask_b32 v8, 0, v8, s[54:55]
    v_cmp_ne_u32 vcc, 0, v8
    s_cbranch_vccz L_h_ok
    s_add_u32 s49, s49, 1
    s_sleep 16
    s_cmp_lt_u32 s49, 40000
    s_cbranch_scc1 L_h_poll
L_h_ok:

    v_add_f32 v28, v28, v30
    v_add_f32 v28, v28, v32
    v_cndmask_b32 v28, 0, v28, s[54:55]
    v_mov_b32 v29, v28
    s_nop 1
    v_permlane32_swap_b32 v28, v29
    v_add_f32 v28, v28, v29

    v_cvt_pk_bf16_f32 v28, v28, v28
    v_and_b32 v28, 0xffff0000, v28

    s_mov_b32 s60, 0x3fb8aa3b
    v_mul_f32 v29, s60, v28
    v_exp_f32 v29, -v29
    s_nop 0
    v_add_f32 v29, 1.0, v29
    v_rcp_f32 v30, v29
    s_nop 0
    v_mul_f32 v31, v28, v30
    v_cvt_pk_bf16_f32 v31, v31, v31
    v_lshrrev_b32 v32, 3, v3
    v_lshl_add_u32 v32, v2, 1, v32
    v_lshlrev_b32 v32, 2, v32
    v_add_u32 v33, 32, v32
    v_add_u32 v34, 64, v32
    ds_bpermute_b32 v36, v32, v31
    ds_bpermute_b32 v37, v33, v31
    ds_bpermute_b32 v38, v34, v31
    s_waitcnt lgkmcnt(0)

    v_and_b32 v24, v36, v12
    v_and_b32 v25, v36, v13
    v_and_b32 v26, v36, v14
    v_and_b32 v27, v36, v15
    s_nop 1
    v_mfma_f32_16x16x32_bf16 v[52:55], v[148:151], v[24:27], v[52:55]
    v_mfma_f32_16x16x32_bf16 v[56:59], v[152:155], v[24:27], v[56:59]
    v_mfma_f32_16x16x32_bf16 v[60:63], v[156:159], v[24:27], v[60:63]
    v_mfma_f32_16x16x32_bf16 v[64:67], v[160:163], v[24:27], v[64:67]
    v_mfma_f32_16x16x32_bf16 v[68:71], v[164:167], v[24:27], v[68:71]
    v_mfma_f32_16x16x32_bf16 v[72:75], v[168:171], v[24:27], v[72:75]
    v_mfma_f32_16x16x32_bf16 v[76:79], v[172:175], v[24:27], v[76:79]
    v_mfma_f32_16x16x32_bf16 v[80:83], v[176:179], v[24:27], v[80:83]
    v_mfma_f32_16x16x32_bf16 v[84:87], v[180:183], v[24:27], v[84:87]
    v_and_b32 v24, v37, v12
    v_and_b32 v25, v37, v13
    v_and_b32 v26, v37, v14
    v_and_b32 v27, v37, v15
    s_nop 1
    v_mfma_f32_16x16x32_bf16 v[52:55], v[184:187], v[24:27], v[52:55]
    v_mfma_f32_16x16x32_bf16 v[56:59], v[188:191], v[24:27], v[56:59]
    v_mfma_f32_16x16x32_bf16 v[60:63], v[192:195], v[24:27], v[60:63]
    v_mfma_f32_16x16x32_bf16 v[64:67], v[196:199], v[24:27], v[64:67]
    v_mfma_f32_16x16x32_bf16 v[68:71], v[200:203], v[24:27], v[68:71]
    v_mfma_f32_16x16x32_bf16 v[72:75], v[204:207], v[24:27], v[72:75]
    v_mfma_f32_16x16x32_bf16 v[76:79], v[208:211], v[24:27], v[76:79]
    v_mfma_f32_16x16x32_bf16 v[80:83], v[212:215], v[24:27], v[80:83]
    v_mfma_f32_16x16x32_bf16 v[84:87], v[216:219], v[24:27], v[84:87]
    v_and_b32 v24, v38, v12
    v_and_b32 v25, v38, v13
    v_and_b32 v26, v38, v14
    v_and_b32 v27, v38, v15
    s_nop 1
    v_mfma_f32_16x16x32_bf16 v[52:55], v[220:223], v[24:27], v[52:55]
    v_mfma_f32_16x16x32_bf16 v[56:59], v[224:227], v[24:27], v[56:59]
    v_mfma_f32_16x16x32_bf16 v[60:63], v[228:231], v[24:27], v[60:63]
    v_mfma_f32_16x16x32_bf16 v[64:67], v[232:235], v[24:27], v[64:67]
    v_mfma_f32_16x16x32_bf16 v[68:71], v[236:239], v[24:27], v[68:71]
    v_mfma_f32_16x16x32_bf16 v[72:75], v[240:243], v[24:27], v[72:75]
    v_mfma_f32_16x16x32_bf16 v[76:79], v[244:247], v[24:27], v[76:79]
    v_mfma_f32_16x16x32_bf16 v[80:83], v[248:251], v[24:27], v[80:83]
    v_mfma_f32_16x16x32_bf16 v[84:87], v[252:255], v[24:27], v[84:87]
    s_nop 5
    v_permlane32_swap_b32 v52, v53
    v_permlane32_swap_b32 v54, v55
    v_permlane32_swap_b32 v56, v57
    v_permlane32_swap_b32 v58, v59
    v_permlane32_swap_b32 v60, v61
    v_permlane32_swap_b32 v62, v63
    v_permlane32_swap_b32 v64, v65
    v_permlane32_swap_b32 v66, v67
    v_permlane32_swap_b32 v68, v69
    v_permlane32_swap_b32 v70, v71
    v_permlane32_swap_b32 v72, v73
    v_permlane32_swap_b32 v74, v75
    v_permlane32_swap_b32 v76, v77
    v_permlane32_swap_b32 v78, v79
    v_permlane32_swap_b32 v80, v81
    v_permlane32_swap_b32 v82, v83
    v_permlane32_swap_b32 v84, v85
    v_permlane32_swap_b32 v86, v87
    v_add_f32_dpp v88, v53, v52 row_ror:8 row_mask:0xf bank_mask:0x3
    v_add_f32_dpp v88, v54, v55 row_ror:8 row_mask:0xf bank_mask:0xc
    v_add_f32_dpp v89, v57, v56 row_ror:8 row_mask:0xf bank_mask:0x3
    v_add_f32_dpp v89, v58, v59 row_ror:8 row_mask:0xf bank_mask:0xc
    v_add_f32_dpp v90, v61, v60 row_ror:8 row_mask:0xf bank_mask:0x3
    v_add_f32_dpp v90, v62, v63 row_ror:8 row_mask:0xf bank_mask:0xc
    v_add_f32_dpp v92, v65, v64 row_ror:8 row_mask:0xf bank_mask:0x3
    v_add_f32_dpp v92, v66, v67 row_ror:8 row_mask:0xf bank_mask:0xc
    v_add_f32_dpp v93, v69, v68 row_ror:8 row_mask:0xf bank_mask:0x3
    v_add_f32_dpp v93, v70, v71 row_ror:8 row_mask:0xf bank_mask:0xc
    v_add_f32_dpp v94, v73, v72 row_ror:8 row_mask:0xf bank_mask:0x3
    v_add_f32_dpp v94, v74, v75 row_ror:8 row_mask:0xf bank_mask:0xc
    v_add_f32_dpp v96, v77, v76 row_ror:8 row_mask:0xf bank_mask:0x3
    v_add_f32_dpp v96, v78, v79 row_ror:8 row_mask:0xf bank_mask:0xc
    v_add_f32_dpp v97, v81, v80 row_ror:8 row_mask:0xf bank_mask:0x3
    v_add_f32_dpp v97, v82, v83 row_ror:8 row_mask:0xf bank_mask:0xc
    v_add_f32_dpp v98, v85, v84 row_ror:8 row_mask:0xf bank_mask:0x3
    v_add_f32_dpp v98, v86, v87 row_ror:8 row_mask:0xf bank_mask:0xc

    s_mov_b32 s32, s8
    s_mov_b32 s33, s9
    s_mov_b32 s34, 1152
    s_mov_b32 s35, 0x20000
    s_lshr_b32 s30, s2, 4
    s_mul_i32 s30, s30, 192
    s_and_b32 s31, s2, 15
    s_lshl_b32 s31, s31, 2
    s_add_u32 s30, s30, s31
    v_and_b32 v10, 3, v0
    v_add_u32 v10, s30, v10
    v_lshlrev_b32 v10, 1, v10
    buffer_load_ushort v12, v10, s[32:35], 0 offen
    buffer_load_ushort v13, v10, s[32:35], 0 offen offset:128
    buffer_load_ushort v14, v10, s[32:35], 0 offen offset:256
    s_mov_b32 s36, s24
    s_mov_b32 s37, s25
    s_mov_b32 s38, 1152
    s_mov_b32 s39, 0x20000

    s_lshl_b32 s30, s2, 14
    v_lshlrev_b32 v4, 4, v0
    v_add_u32 v4, s30, v4
    v_add_u32 v5, 4096, v4
    v_add_u32 v6, 8192, v4
    v_add_u32 v7, 12288, v4

    s_mov_b32 s88, 7602176
    s_mov_b32 s89, 6291456
    s_waitcnt vmcnt(0)
    v_lshlrev_b32 v12, 16, v12
    v_lshlrev_b32 v13, 16, v13
    v_lshlrev_b32 v14, 16, v14
    s_barrier
    v_mov_b32 v44, 324
    s_mov_b32 s49, 0
L_ybw:
    ds_read_b32 v45, v44
    s_add_u32 s49, s49, 1
    s_waitcnt lgkmcnt(0)
    v_readfirstlane_b32 s30, v45
    s_cmp_ge_u32 s49, 640000
    s_cbranch_scc1 L_ybd
    s_cmp_eq_u32 s30, 2
    s_cbranch_scc0 L_ybw
L_ybd:
    s_mov_b32 s31, 0
    buffer_store_dwordx4 v[88:91], v20, s[44:47], s31 offen sc1
    s_mov_b32 s31, 262144
    buffer_store_dwordx4 v[92:95], v20, s[44:47], s31 offen sc1
    s_mov_b32 s31, 524288
    buffer_store_dwordx4 v[96:99], v20, s[44:47], s31 offen sc1
    s_cmp_lt_u32 s2, 48
    s_cbranch_scc0 L_notred2
    s_mov_b32 s49, 0
L_yb_poll:
    buffer_load_dwordx4 v[164:167], v4, s[44:47], s88 offen offset:0 sc1
    buffer_load_dwordx4 v[168:171], v4, s[44:47], s88 offen offset:1024 sc1
    buffer_load_dwordx4 v[172:175], v4, s[44:47], s88 offen offset:2048 sc1
    buffer_load_dwordx4 v[176:179], v4, s[44:47], s88 offen offset:3072 sc1
    buffer_load_dwordx4 v[180:183], v5, s[44:47], s88 offen offset:0 sc1
    buffer_load_dwordx4 v[184:187], v5, s[44:47], s88 offen offset:1024 sc1
    buffer_load_dwordx4 v[188:191], v5, s[44:47], s88 offen offset:2048 sc1
    buffer_load_dwordx4 v[192:195], v5, s[44:47], s88 offen offset:3072 sc1
    buffer_load_dwordx4 v[196:199], v6, s[44:47], s88 offen offset:0 sc1
    buffer_load_dwordx4 v[200:203], v6, s[44:47], s88 offen offset:1024 sc1
    buffer_load_dwordx4 v[204:207], v6, s[44:47], s88 offen offset:2048 sc1
    buffer_load_dwordx4 v[208:211], v6, s[44:47], s88 offen offset:3072 sc1
    buffer_load_dwordx4 v[212:215], v7, s[44:47], s88 offen offset:0 sc1
    buffer_load_dwordx4 v[216:219], v7, s[44:47], s88 offen offset:1024 sc1
    buffer_load_dwordx4 v[220:223], v7, s[44:47], s88 offen offset:2048 sc1
    buffer_load_dwordx4 v[224:227], v7, s[44:47], s88 offen offset:3072 sc1
    s_waitcnt vmcnt(0)
    v_xor_b32 v8, s6, v167
    v_xor_b32 v46, s6, v171
    v_or_b32 v8, v8, v46
    v_xor_b32 v46, s6, v175
    v_xor_b32 v47, s6, v179
    v_or3_b32 v8, v8, v46, v47
    v_xor_b32 v46, s6, v183
    v_xor_b32 v47, s6, v187
    v_or3_b32 v8, v8, v46, v47
    v_xor_b32 v46, s6, v191
    v_xor_b32 v47, s6, v195
    v_or3_b32 v8, v8, v46, v47
    v_xor_b32 v46, s6, v199
    v_xor_b32 v47, s6, v203
    v_or3_b32 v8, v8, v46, v47
    v_xor_b32 v46, s6, v207
    v_xor_b32 v47, s6, v211
    v_or3_b32 v8, v8, v46, v47
    v_xor_b32 v46, s6, v215
    v_xor_b32 v47, s6, v219
    v_or3_b32 v8, v8, v46, v47
    v_xor_b32 v46, s6, v223
    v_xor_b32 v47, s6, v227
    v_or3_b32 v8, v8, v46, v47
    v_cmp_ne_u32 vcc, 0, v8
    s_cbranch_vccz L_yb_ok
    s_add_u32 s49, s49, 1
    s_cmp_lt_u32 s49, 40000
    s_cbranch_scc1 L_yb_poll
L_yb_ok:
    buffer_load_dwordx4 v[100:103], v4, s[44:47], s89 offen offset:0 sc1
    buffer_load_dwordx4 v[104:107], v4, s[44:47], s89 offen offset:1024 sc1
    buffer_load_dwordx4 v[108:111], v4, s[44:47], s89 offen offset:2048 sc1
    buffer_load_dwordx4 v[112:115], v4, s[44:47], s89 offen offset:3072 sc1
    buffer_load_dwordx4 v[116:119], v5, s[44:47], s89 offen offset:0 sc1
    buffer_load_dwordx4 v[120:123], v5, s[44:47], s89 offen offset:1024 sc1
    buffer_load_dwordx4 v[124:127], v5, s[44:47], s89 offen offset:2048 sc1
    buffer_load_dwordx4 v[128:131], v5, s[44:47], s89 offen offset:3072 sc1
    buffer_load_dwordx4 v[132:135], v6, s[44:47], s89 offen offset:0 sc1
    buffer_load_dwordx4 v[136:139], v6, s[44:47], s89 offen offset:1024 sc1
    buffer_load_dwordx4 v[140:143], v6, s[44:47], s89 offen offset:2048 sc1
    buffer_load_dwordx4 v[144:147], v6, s[44:47], s89 offen offset:3072 sc1
    buffer_load_dwordx4 v[148:151], v7, s[44:47], s89 offen offset:0 sc1
    buffer_load_dwordx4 v[152:155], v7, s[44:47], s89 offen offset:1024 sc1
    buffer_load_dwordx4 v[156:159], v7, s[44:47], s89 offen offset:2048 sc1
    buffer_load_dwordx4 v[160:163], v7, s[44:47], s89 offen offset:3072 sc1
    v_pk_add_f32 v[164:165], v[164:165], v[168:169]
    v_add_f32 v166, v166, v170
    v_pk_add_f32 v[172:173], v[172:173], v[176:177]
    v_add_f32 v174, v174, v178
    v_pk_add_f32 v[180:181], v[180:181], v[184:185]
    v_add_f32 v182, v182, v186
    v_pk_add_f32 v[188:189], v[188:189], v[192:193]
    v_add_f32 v190, v190, v194
    v_pk_add_f32 v[196:197], v[196:197], v[200:201]
    v_add_f32 v198, v198, v202
    v_pk_add_f32 v[204:205], v[204:205], v[208:209]
    v_add_f32 v206, v206, v210
    v_pk_add_f32 v[212:213], v[212:213], v[216:217]
    v_add_f32 v214, v214, v218
    v_pk_add_f32 v[220:221], v[220:221], v[224:225]
    v_add_f32 v222, v222, v226
    v_pk_add_f32 v[164:165], v[164:165], v[172:173]
    v_add_f32 v166, v166, v174
    v_pk_add_f32 v[180:181], v[180:181], v[188:189]
    v_add_f32 v182, v182, v190
    v_pk_add_f32 v[196:197], v[196:197], v[204:205]
    v_add_f32 v198, v198, v206
    v_pk_add_f32 v[212:213], v[212:213], v[220:221]
    v_add_f32 v214, v214, v222
    v_pk_add_f32 v[164:165], v[164:165], v[180:181]
    v_add_f32 v166, v166, v182
    v_pk_add_f32 v[196:197], v[196:197], v[212:213]
    v_add_f32 v198, v198, v214
    v_pk_add_f32 v[164:165], v[164:165], v[196:197]
    v_add_f32 v166, v166, v198
    s_nop 0
    v_add_f32_dpp v164, v164, v164 row_ror:4 row_mask:0xf bank_mask:0xf
    v_add_f32_dpp v165, v165, v165 row_ror:4 row_mask:0xf bank_mask:0xf
    v_add_f32_dpp v166, v166, v166 row_ror:4 row_mask:0xf bank_mask:0xf
    v_add_f32_dpp v164, v164, v164 row_ror:8 row_mask:0xf bank_mask:0xf
    v_add_f32_dpp v165, v165, v165 row_ror:8 row_mask:0xf bank_mask:0xf
    v_add_f32_dpp v166, v166, v166 row_ror:8 row_mask:0xf bank_mask:0xf
    v_mov_b32 v168, v164
    v_mov_b32 v169, v165
    v_mov_b32 v170, v166
    v_permlane16_swap_b32 v164, v168
    v_permlane16_swap_b32 v165, v169
    v_permlane16_swap_b32 v166, v170
    v_add_f32 v164, v164, v168
    v_add_f32 v165, v165, v169
    v_add_f32 v166, v166, v170
    v_mov_b32 v168, v164
    v_mov_b32 v169, v165
    v_mov_b32 v170, v166
    v_permlane32_swap_b32 v164, v168
    v_permlane32_swap_b32 v165, v169
    v_permlane32_swap_b32 v166, v170
    v_add_f32 v164, v164, v168
    v_add_f32 v165, v165, v169
    v_add_f32 v166, v166, v170
    v_cvt_pk_bf16_f32 v40, v164, v164
    v_cvt_pk_bf16_f32 v41, v165, v165
    v_cvt_pk_bf16_f32 v42, v166, v166
    v_and_b32 v40, 0xffff0000, v40
    v_and_b32 v41, 0xffff0000, v41
    v_and_b32 v42, 0xffff0000, v42
    s_mov_b32 s49, 0
    s_branch L_ya_chk
L_ya_poll:
    buffer_load_dwordx4 v[100:103], v4, s[44:47], s89 offen offset:0 sc1
    buffer_load_dwordx4 v[104:107], v4, s[44:47], s89 offen offset:1024 sc1
    buffer_load_dwordx4 v[108:111], v4, s[44:47], s89 offen offset:2048 sc1
    buffer_load_dwordx4 v[112:115], v4, s[44:47], s89 offen offset:3072 sc1
    buffer_load_dwordx4 v[116:119], v5, s[44:47], s89 offen offset:0 sc1
    buffer_load_dwordx4 v[120:123], v5, s[44:47], s89 offen offset:1024 sc1
    buffer_load_dwordx4 v[124:127], v5, s[44:47], s89 offen offset:2048 sc1
    buffer_load_dwordx4 v[128:131], v5, s[44:47], s89 offen offset:3072 sc1
    buffer_load_dwordx4 v[132:135], v6, s[44:47], s89 offen offset:0 sc1
    buffer_load_dwordx4 v[136:139], v6, s[44:47], s89 offen offset:1024 sc1
    buffer_load_dwordx4 v[140:143], v6, s[44:47], s89 offen offset:2048 sc1
    buffer_load_dwordx4 v[144:147], v6, s[44:47], s89 offen offset:3072 sc1
    buffer_load_dwordx4 v[148:151], v7, s[44:47], s89 offen offset:0 sc1
    buffer_load_dwordx4 v[152:155], v7, s[44:47], s89 offen offset:1024 sc1
    buffer_load_dwordx4 v[156:159], v7, s[44:47], s89 offen offset:2048 sc1
    buffer_load_dwordx4 v[160:163], v7, s[44:47], s89 offen offset:3072 sc1
L_ya_chk:
    s_waitcnt vmcnt(0)
    v_xor_b32 v8, s6, v103
    v_xor_b32 v46, s6, v107
    v_or_b32 v8, v8, v46
    v_xor_b32 v46, s6, v111
    v_xor_b32 v47, s6, v115
    v_or3_b32 v8, v8, v46, v47
    v_xor_b32 v46, s6, v119
    v_xor_b32 v47, s6, v123
    v_or3_b32 v8, v8, v46, v47
    v_xor_b32 v46, s6, v127
    v_xor_b32 v47, s6, v131
    v_or3_b32 v8, v8, v46, v47
    v_xor_b32 v46, s6, v135
    v_xor_b32 v47, s6, v139
    v_or3_b32 v8, v8, v46, v47
    v_xor_b32 v46, s6, v143
    v_xor_b32 v47, s6, v147
    v_or3_b32 v8, v8, v46, v47
    v_xor_b32 v46, s6, v151
    v_xor_b32 v47, s6, v155
    v_or3_b32 v8, v8, v46, v47
    v_xor_b32 v46, s6, v159
    v_xor_b32 v47, s6, v163
    v_or3_b32 v8, v8, v46, v47
    v_cmp_ne_u32 vcc, 0, v8
    s_cbranch_vccz L_ya_ok
    s_add_u32 s49, s49, 1
    s_cmp_lt_u32 s49, 40000
    s_cbranch_scc1 L_ya_poll
L_ya_ok:
    v_pk_add_f32 v[100:101], v[100:101], v[104:105]
    v_add_f32 v102, v102, v106
    v_pk_add_f32 v[108:109], v[108:109], v[112:113]
    v_add_f32 v110, v110, v114
    v_pk_add_f32 v[116:117], v[116:117], v[120:121]
    v_add_f32 v118, v118, v122
    v_pk_add_f32 v[124:125], v[124:125], v[128:129]
    v_add_f32 v126, v126, v130
    v_pk_add_f32 v[132:133], v[132:133], v[136:137]
    v_add_f32 v134, v134, v138
    v_pk_add_f32 v[140:141], v[140:141], v[144:145]
    v_add_f32 v142, v142, v146
    v_pk_add_f32 v[148:149], v[148:149], v[152:153]
    v_add_f32 v150, v150, v154
    v_pk_add_f32 v[156:157], v[156:157], v[160:161]
    v_add_f32 v158, v158, v162
    v_pk_add_f32 v[100:101], v[100:101], v[108:109]
    v_add_f32 v102, v102, v110
    v_pk_add_f32 v[116:117], v[116:117], v[124:125]
    v_add_f32 v118, v118, v126
    v_pk_add_f32 v[132:133], v[132:133], v[140:141]
    v_add_f32 v134, v134, v142
    v_pk_add_f32 v[148:149], v[148:149], v[156:157]
    v_add_f32 v150, v150, v158
    v_pk_add_f32 v[100:101], v[100:101], v[116:117]
    v_add_f32 v102, v102, v118
    v_pk_add_f32 v[132:133], v[132:133], v[148:149]
    v_add_f32 v134, v134, v150
    v_pk_add_f32 v[100:101], v[100:101], v[132:133]
    v_add_f32 v102, v102, v134
    s_nop 0
    v_add_f32_dpp v100, v100, v100 row_ror:4 row_mask:0xf bank_mask:0xf
    v_add_f32_dpp v101, v101, v101 row_ror:4 row_mask:0xf bank_mask:0xf
    v_add_f32_dpp v102, v102, v102 row_ror:4 row_mask:0xf bank_mask:0xf
    v_add_f32_dpp v100, v100, v100 row_ror:8 row_mask:0xf bank_mask:0xf
    v_add_f32_dpp v101, v101, v101 row_ror:8 row_mask:0xf bank_mask:0xf
    v_add_f32_dpp v102, v102, v102 row_ror:8 row_mask:0xf bank_mask:0xf
    v_mov_b32 v104, v100
    v_mov_b32 v105, v101
    v_mov_b32 v106, v102
    v_permlane16_swap_b32 v100, v104
    v_permlane16_swap_b32 v101, v105
    v_permlane16_swap_b32 v102, v106
    v_add_f32 v100, v100, v104
    v_add_f32 v101, v101, v105
    v_add_f32 v102, v102, v106
    v_mov_b32 v104, v100
    v_mov_b32 v105, v101
    v_mov_b32 v106, v102
    v_permlane32_swap_b32 v100, v104
    v_permlane32_swap_b32 v101, v105
    v_permlane32_swap_b32 v102, v106
    v_add_f32 v100, v100, v104
    v_add_f32 v101, v101, v105
    v_add_f32 v102, v102, v106
    v_cvt_pk_bf16_f32 v24, v100, v100
    v_cvt_pk_bf16_f32 v25, v101, v101
    v_cvt_pk_bf16_f32 v26, v102, v102
    v_and_b32 v24, 0xffff0000, v24
    v_and_b32 v25, 0xffff0000, v25
    v_and_b32 v26, 0xffff0000, v26
    v_add_f32 v24, v12, v24
    v_add_f32 v25, v13, v25
    v_add_f32 v26, v14, v26
    v_cvt_pk_bf16_f32 v24, v24, v24
    v_cvt_pk_bf16_f32 v25, v25, v25
    v_cvt_pk_bf16_f32 v26, v26, v26
    v_and_b32 v24, 0xffff0000, v24
    v_and_b32 v25, 0xffff0000, v25
    v_and_b32 v26, 0xffff0000, v26
    v_add_f32 v24, v24, v40
    v_add_f32 v25, v25, v41
    v_add_f32 v26, v26, v42
    v_cvt_pk_bf16_f32 v24, v24, v24
    v_cvt_pk_bf16_f32 v25, v25, v25
    v_cvt_pk_bf16_f32 v26, v26, v26

    s_mov_b64 exec, 15
    buffer_store_short v24, v10, s[36:39], 0 offen
    buffer_store_short v25, v10, s[36:39], 0 offen offset:128
    buffer_store_short v26, v10, s[36:39], 0 offen offset:256
    s_mov_b64 exec, -1
    s_cmp_eq_u32 s2, 0
    s_cbranch_scc0 L_notred2
    v_mov_b32 v4, 0
    v_mov_b32 v5, s6
    s_mov_b64 exec, 1
    buffer_store_dword v5, v4, s[44:47], 0 offen sc1
    s_mov_b64 exec, -1
L_notred2:

L_end:
    s_endpgm

.section .rodata,"a"
.p2align 6
.amdhsa_kernel parallel_sum__mha_block_cached__dense_activation_silu__decode_kernel
  .amdhsa_next_free_vgpr 256
  .amdhsa_next_free_sgpr 96
  .amdhsa_accum_offset 256
  .amdhsa_group_segment_fixed_size 0
  .amdhsa_kernarg_size 88
  .amdhsa_user_sgpr_count 2
  .amdhsa_user_sgpr_kernarg_segment_ptr 1
  .amdhsa_system_sgpr_workgroup_id_x 1
.end_amdhsa_kernel
```
